```python
import torch

def _softmax(x, axis=-1):
    return torch.softmax(x, dim=axis)
def _gelu(x):
    return torch.nn.functional.gelu(x, approximate="tanh")
def _silu(x):
    return torch.nn.functional.silu(x)
def _sigmoid(x):
    return torch.sigmoid(x)
def _layernorm(x, axis=-1, eps=1e-5):
    m = x.mean(dim=axis, keepdim=True)
    v = x.var(dim=axis, keepdim=True, unbiased=False)
    return (x - m) / torch.sqrt(v + eps)
def _scatter_add(tgt, idx, src, axis=0):
    return tgt.clone().index_add_(axis, idx, src)
def _segment_sum(src, seg, n):
    out = torch.zeros((n,) + src.shape[1:], dtype=src.dtype)
    return out.index_add_(0, seg, src)
def _pad(x, pw):
    flat = tuple(v for pair in reversed(pw) for v in pair)
    return torch.nn.functional.pad(x, flat)

kernel_name = 'gated_mix__grouped_kv_mqa__sliding_block__prompt'

def setup_inputs():

    _w = (lambda a: (lambda t: t.to(torch.bfloat16) if t.is_floating_point() else t)(torch.as_tensor(a)))
    def _A_setup():
        B, S, D, H = 1, 2048, 640, 32
        Dh = D // H
        return {
            "x": _w((lambda *s: torch.randn(*s, dtype=torch.bfloat16) * 0.05)(B, S, D)),
            "wq": _w((lambda *s: torch.randn(*s, dtype=torch.bfloat16) * 3.2)(D, H * Dh)),
            "wk": _w((lambda *s: torch.randn(*s, dtype=torch.bfloat16) * 3.2)(D, Dh)),
            "wv": _w((lambda *s: torch.randn(*s, dtype=torch.bfloat16) * 0.4)(D, Dh)),
            "wo": _w((lambda *s: torch.randn(*s, dtype=torch.bfloat16) * 0.4)(H * Dh, D)),
        }
    _A_in = _A_setup()

    def _B_setup():
        B, S, D = 1, 2048, 640
        return {
            "x": _w((lambda *s: torch.randn(*s, dtype=torch.bfloat16) * 0.05)(B, S, D)),
            "wqkv": _w((lambda *s: torch.randn(*s, dtype=torch.bfloat16) * 1.6)(D, 3 * D)),
            "wo": _w((lambda *s: torch.randn(*s, dtype=torch.bfloat16) * 0.4)(D, D)),
        }
    _B_in = _B_setup()

    return {
        "A_x": _A_in["x"],
        "A_wq": _A_in["wq"],
        "A_wk": _A_in["wk"],
        "A_wv": _A_in["wv"],
        "A_wo": _A_in["wo"],
        "B_x": _B_in["x"],
        "B_wqkv": _B_in["wqkv"],
        "B_wo": _B_in["wo"],
        "gate_w": _w((lambda *s: torch.randn(*s, dtype=torch.bfloat16) * 0.8)(640) * 16.0),
    }

def reference(A_x, A_wq, A_wk, A_wv, A_wo, B_x, B_wqkv, B_wo, gate_w):
    def _A_ref(x, wq, wk, wv, wo):
        B, S, D = x.shape
        H = 32
        Dh = D // H
        q = (lambda x, *d: x.permute(*d))((x @ wq).reshape(B, S, H, Dh), 0, 2, 1, 3)
        k = x @ wk
        v = x @ wv
        scores = torch.einsum("bhqd,bkd->bhqk", q, k) * (Dh ** -0.5)
        p = _softmax(scores, axis=-1)
        o = torch.einsum("bhqk,bkd->bhqd", p, v)
        return (lambda x, *d: x.permute(*d))(o, 0, 2, 1, 3).reshape(B, S, H * Dh) @ wo

    def _B_ref(x, wqkv, wo):
        B, S, D = x.shape
        H = 32; Dh = D // H; W = 256
        qkv = (lambda x, *d: x.permute(*d))((x @ wqkv).reshape(B, S, 3, H, Dh), 2, 0, 3, 1, 4)
        q, k, v = qkv[0], qkv[1], qkv[2]
        scores = torch.einsum("bhqd,bhkd->bhqk", q, k) * (Dh ** -0.5)
        idx = torch.arange(S)
        mask = (idx[:, None] - idx[None, :] >= 0) & (idx[:, None] - idx[None, :] < W)
        scores = torch.where(mask[None, None], scores, -1e9)
        p = _softmax(scores, axis=-1)
        o = torch.einsum("bhqk,bhkd->bhqd", p, v)
        return (lambda x, *d: x.permute(*d))(o, 0, 2, 1, 3).reshape(B, S, D) @ wo

    x = A_x
    g = _sigmoid((x * gate_w).sum(-1, keepdims=True))
    a = _A_ref(x, A_wq, A_wk, A_wv, A_wo)
    b = _B_ref(x, B_wqkv, B_wo)
    return g * a + (1 - g) * b
```

```asm
; @launch kernel=proj_kernel grid=(256,1,1) block=(1024,1,1) lds=159744
; @launch kernel=attn_kernel grid=(256,1,1) block=(768,1,1) lds=147456
; @launch kernel=oproj_kernel grid=(256,1,1) block=(512,1,1) lds=102400
.amdgcn_target "amdgcn-amd-amdhsa--gfx950"
.text
.globl proj_kernel
.p2align 8
.type proj_kernel,@function
proj_kernel:
s_cmp_ge_u32 s2, 256
s_cbranch_scc1 K1_END
s_load_dwordx4 s[44:47], s[0:1], 0
s_load_dwordx4 s[48:51], s[0:1], 16
s_load_dwordx2 s[52:53], s[0:1], 48
s_load_dwordx2 s[54:55], s[0:1], 64
s_load_dwordx2 s[56:57], s[0:1], 88
s_and_b32 s3, s2, 7
s_lshr_b32 s4, s2, 3
s_and_b32 s24, s3, 1
s_lshl_b32 s24, s24, 3
s_and_b32 s5, s4, 7
s_add_u32 s24, s24, s5
s_lshr_b32 s25, s3, 1
s_lshl_b32 s25, s25, 2
s_lshr_b32 s5, s4, 3
s_add_u32 s25, s25, s5
v_lshrrev_b32 v1, 6, v0
v_and_b32 v0, 63, v0
s_nop 0
v_readfirstlane_b32 s68, v1
s_waitcnt lgkmcnt(0)
s_and_b32 s65, s68, 7
s_and_b32 s26, s65, 3
s_lshr_b32 s66, s65, 2
s_mov_b32 s8, s44
s_and_b32 s9, s45, 0xffff
s_mov_b32 s10, 2621440
s_mov_b32 s11, 0x20000
s_mov_b32 s20, s56
s_and_b32 s21, s57, 0xffff
s_mov_b32 s22, 0x10000000
s_mov_b32 s23, 0x20000
s_cmp_lt_u32 s25, 4
s_cselect_b32 s12, s46, s52
s_cselect_b32 s13, s47, s53
s_mov_b32 s38, 2457600
s_cselect_b32 s38, 819200, s38
s_mov_b32 s33, 3840
s_cselect_b32 s33, 1280, s33
s_cselect_b32 s5, 0, 4
s_and_b32 s13, s13, 0xffff
s_mov_b32 s14, s38
s_mov_b32 s15, 0x20000
s_sub_u32 s5, s25, s5
s_mul_i32 s58, s5, 320
s_lshr_b32 s70, s25, 2
s_cmp_eq_u32 s70, 0
s_cselect_b32 s16, s48, s50
s_cselect_b32 s17, s49, s51
s_cmp_ge_u32 s70, 2
s_cselect_b32 s16, s54, s16
s_cselect_b32 s17, s55, s17
s_mov_b32 s39, 25600
s_cselect_b32 s39, 1280, s39
s_mov_b32 s34, 2560
s_cselect_b32 s34, 128, s34
s_cselect_b32 s36, 0xff, -1
s_cselect_b32 s37, 0, 0xff
s_cselect_b32 s59, 0, 640
s_and_b32 s17, s17, 0xffff
s_mov_b32 s18, s39
s_mov_b32 s19, 0x20000
s_mov_b32 s40, 2621440
s_mul_i32 s59, s59, s26
s_add_u32 s43, s59, 36864
s_lshl_b32 s41, s65, 11
s_mul_i32 s3, s26, 3
s_lshl_b32 s4, s26, 1
s_add_u32 s4, s4, 12
s_cmp_eq_u32 s66, 0
s_cselect_b32 s67, s3, s4
s_lshl_b32 s42, s67, 10
s_add_u32 s42, s42, 16384
s_cmp_ge_u32 s70, 3
s_cselect_b32 s39, 0, s39
s_mov_b32 s18, s39
s_lshl_b32 s3, s24, 7
s_lshl_b32 s4, s26, 5
s_add_u32 s60, s3, s4
s_cmp_lt_u32 s68, 8
s_cbranch_scc1 K1_CONS
v_lshrrev_b32 v104, 3, v0
v_lshrrev_b32 v105, 4, v0
v_and_b32 v106, 7, v0
s_lshl_b32 s3, s24, 7
s_lshl_b32 s4, s26, 5
s_add_u32 s60, s3, s4
s_lshl_b32 s4, s65, 4
s_add_u32 s3, s3, s4
v_add_u32 v107, s3, v104
v_mul_u32_u24 v107, 1280, v107
v_xor_b32 v108, v106, v105
v_lshl_add_u32 v2, v108, 4, v107
v_xor_b32 v108, 4, v108
v_lshl_add_u32 v3, v108, 4, v107
s_lshl_b32 s3, s67, 6
v_add_u32 v107, s3, v0
v_add_u32 v107, 0, v107
v_mul_u32_u24 v108, 52429, v107
v_lshrrev_b32 v108, 20, v108
v_mul_u32_u24 v109, 20, v108
v_sub_u32 v109, v107, v109
v_mul_u32_u24 v108, s33, v108
v_lshl_add_u32 v108, v109, 4, v108
v_add_u32 v4, s58, v108
v_add_u32 v107, s3, v0
v_add_u32 v107, 64, v107
v_mul_u32_u24 v108, 52429, v107
v_lshrrev_b32 v108, 20, v108
v_mul_u32_u24 v109, 20, v108
v_sub_u32 v109, v107, v109
v_mul_u32_u24 v108, s33, v108
v_lshl_add_u32 v108, v109, 4, v108
v_add_u32 v5, s58, v108
v_add_u32 v107, s3, v0
v_add_u32 v107, 128, v107
v_mul_u32_u24 v108, 52429, v107
v_lshrrev_b32 v108, 20, v108
v_mul_u32_u24 v109, 20, v108
v_sub_u32 v109, v107, v109
v_mul_u32_u24 v108, s33, v108
v_lshl_add_u32 v108, v109, 4, v108
v_add_u32 v6, s58, v108
v_lshlrev_b32 v9, 4, v0
v_add_u32 v9, s59, v9
s_mul_i32 s35, s33, 64
s_branch K1_PROD
K1_CONS:
s_cmp_lt_u32 s68, 4
s_cbranch_scc0 K1_PF1e
s_lshl_b32 s3, s2, 2
s_add_u32 s3, s3, s68
s_mul_i32 s3, s3, 20
v_add_u32 v112, s3, v0
v_lshlrev_b32 v112, 7, v112
s_mov_b32 exec_lo, 0xfffff
s_mov_b32 exec_hi, 0
buffer_load_dword v116, v112, s[8:11], 0 offen
s_branch K1_PF2e
K1_PF1e:
s_mul_i32 s3, s2, 3
s_add_u32 s3, s3, s68
s_sub_u32 s3, s3, 5
s_cmp_eq_u32 s68, 4
s_cselect_b32 s3, s2, s3
s_cselect_b32 s72, s46, s52
s_cselect_b32 s73, s47, s53
s_mov_b32 s74, 2457600
s_cselect_b32 s74, 819200, s74
s_and_b32 s73, s73, 0xffff
s_mov_b32 s75, 0x20000
s_mul_i32 s3, s3, 25
v_add_u32 v112, s3, v0
v_lshlrev_b32 v112, 7, v112
s_mov_b32 exec_lo, 0x1ffffff
s_mov_b32 exec_hi, 0
buffer_load_dword v116, v112, s[72:75], 0 offen
K1_PF2e:
s_mov_b64 exec, -1
s_cmp_eq_u32 s68, 5
s_cbranch_scc0 K1_PFE
s_cmp_lt_u32 s2, 9
s_cbranch_scc0 K1_PFE
s_cmp_lt_u32 s2, 4
s_cselect_b32 s76, s48, s50
s_cselect_b32 s77, s49, s51
s_mov_b32 s78, 25600
s_cmp_eq_u32 s2, 8
s_cselect_b32 s76, s54, s76
s_cselect_b32 s77, s55, s77
s_cselect_b32 s78, 1280, s78
s_and_b32 s77, s77, 0xffff
s_mov_b32 s79, 0x20000
s_and_b32 s3, s2, 3
s_lshl_b32 s3, s3, 6
v_add_u32 v112, s3, v0
v_lshlrev_b32 v112, 7, v112
buffer_load_dword v115, v112, s[76:79], 0 offen
K1_PFE:
s_cmp_eq_u32 s68, 3
s_cbranch_scc0 K1_TW1
v_lshlrev_b32 v112, 21, v0
s_mov_b32 exec_lo, 0x7ff
s_mov_b32 exec_hi, 0
buffer_load_dword v113, v112, s[20:23], 0 offen
s_mov_b64 exec, -1
K1_TW1:
s_cmp_eq_u32 s68, 4
s_cbranch_scc0 K1_TW2
s_load_dwordx2 s[76:77], s[0:1], 72
s_load_dwordx2 s[4:5], s[0:1], 32
s_load_dwordx2 s[6:7], s[0:1], 56
s_waitcnt lgkmcnt(0)
s_mov_b32 s80, s76
s_and_b32 s81, s77, 0xffff
s_mov_b32 s82, 2621440
s_mov_b32 s83, 0x20000
v_lshlrev_b32 v112, 21, v0
s_mov_b32 exec_lo, 0x3
s_mov_b32 exec_hi, 0
buffer_load_dword v113, v112, s[80:83], 0 offen
s_mov_b32 exec_lo, 0x1
s_nop 0
global_load_dword v114, v112, s[4:5]
global_load_dword v115, v112, s[6:7]
s_mov_b64 exec, -1
K1_TW2:
v_lshrrev_b32 v105, 4, v0
v_and_b32 v104, 31, v0
v_lshrrev_b32 v106, 5, v0
s_lshl_b32 s3, s26, 12
v_lshlrev_b32 v107, 7, v104
v_add_u32 v107, s3, v107
v_lshrrev_b32 v108, 1, v0
v_and_b32 v108, 7, v108
v_xor_b32 v108, v108, v106
v_xor_b32 v109, 0, v108
v_lshl_add_u32 v10, v109, 4, v107
v_xor_b32 v109, 2, v108
v_lshl_add_u32 v11, v109, 4, v107
v_xor_b32 v109, 4, v108
v_lshl_add_u32 v12, v109, 4, v107
v_xor_b32 v109, 6, v108
v_lshl_add_u32 v13, v109, 4, v107
v_bfe_u32 v107, v0, 2, 2
v_lshl_add_u32 v107, v106, 3, v107
v_and_b32 v108, 1, v105
v_lshlrev_b32 v108, 5, v108
v_and_b32 v109, 3, v0
v_lshl_add_u32 v108, v109, 3, v108
v_mul_u32_u24 v109, 320, v107
v_add3_u32 v14, v109, v108, 64
v_add_u32 v14, 16320, v14
v_mul_u32_u24 v109, 40, v107
v_add_u32 v109, v109, v108
v_lshlrev_b32 v110, 4, v106
s_cmp_eq_u32 s70, 2
s_cselect_b64 s[4:5], -1, 0
s_cselect_b32 s3, 32, 640
s_mul_i32 s3, s3, s26
s_add_u32 s3, s3, 36864
v_cndmask_b32 v109, v109, v110, s[4:5]
v_add_u32 v15, s3, v109
v_lshrrev_b32 v108, 1, v0
v_and_b32 v108, 7, v108
v_xor_b32 v108, v108, v106
s_lshl_b32 s3, s26, 1
v_xor_b32 v108, s3, v108
s_and_b32 s3, s25, 3
s_lshl_b32 s3, s3, 12
v_lshlrev_b32 v107, 7, v104
v_add_u32 v107, s3, v107
v_lshl_add_u32 v22, v108, 4, v107
s_cmp_eq_u32 s66, 0
s_cbranch_scc0 K1_FH1
s_cmp_ge_u32 s25, 12
s_cbranch_scc1 K1_V6
s_branch K1_V5
K1_FH1:
s_cmp_eq_u32 s70, 0
s_cbranch_scc1 K1_V0
s_cmp_eq_u32 s70, 1
s_cbranch_scc1 K1_V1
s_cmp_eq_u32 s70, 2
s_cbranch_scc1 K1_V2
s_branch K1_V4
K1_PROD:
s_mov_b32 s29, 0
s_mov_b32 s27, 0
s_mov_b32 s69, 0
s_lshl_b32 s30, s69, 7
s_mul_i32 s31, s69, s35
s_mul_i32 s32, s69, s34
s_cmp_eq_u32 s66, 0
s_cbranch_scc0 K1_PROD1
s_add_u32 s3, s29, s41
s_add_u32 m0, s3, 0
s_add_u32 s4, s30, 0
buffer_load_dwordx4 v2, s[8:11], s4 offen lds
s_add_u32 s3, s29, s41
s_add_u32 m0, s3, 1024
s_add_u32 s4, s30, 10240
buffer_load_dwordx4 v3, s[8:11], s4 offen lds
s_add_u32 s3, s29, s42
s_add_u32 m0, s3, 0
s_nop 0
buffer_load_dwordx4 v4, s[12:15], s31 offen lds
s_add_u32 s3, s29, s42
s_add_u32 m0, s3, 1024
s_nop 0
buffer_load_dwordx4 v5, s[12:15], s31 offen lds
s_add_u32 s3, s29, s42
s_add_u32 m0, s3, 2048
s_nop 0
buffer_load_dwordx4 v6, s[12:15], s31 offen lds
s_add_u32 s27, s27, 1
s_add_u32 s29, s29, 39936
s_cmp_eq_u32 s29, 159744
s_cselect_b32 s29, 0, s29
s_add_u32 s30, s30, 128
s_add_u32 s31, s31, s35
s_add_u32 s32, s32, s34
s_cmp_lt_u32 s27, 10
s_cselect_b32 s10, s40, 0
s_cselect_b32 s14, s38, 0
s_cselect_b32 s18, s39, 0
s_cmp_lt_u32 s30, 1280
s_cselect_b32 s30, s30, 0
s_cselect_b32 s31, s31, 0
s_cselect_b32 s32, s32, 0
s_add_u32 s3, s29, s41
s_add_u32 m0, s3, 0
s_add_u32 s4, s30, 0
buffer_load_dwordx4 v2, s[8:11], s4 offen lds
s_add_u32 s3, s29, s41
s_add_u32 m0, s3, 1024
s_add_u32 s4, s30, 10240
buffer_load_dwordx4 v3, s[8:11], s4 offen lds
s_add_u32 s3, s29, s42
s_add_u32 m0, s3, 0
s_nop 0
buffer_load_dwordx4 v4, s[12:15], s31 offen lds
s_add_u32 s3, s29, s42
s_add_u32 m0, s3, 1024
s_nop 0
buffer_load_dwordx4 v5, s[12:15], s31 offen lds
s_add_u32 s3, s29, s42
s_add_u32 m0, s3, 2048
s_nop 0
buffer_load_dwordx4 v6, s[12:15], s31 offen lds
s_add_u32 s27, s27, 1
s_add_u32 s29, s29, 39936
s_cmp_eq_u32 s29, 159744
s_cselect_b32 s29, 0, s29
s_add_u32 s30, s30, 128
s_add_u32 s31, s31, s35
s_add_u32 s32, s32, s34
s_cmp_lt_u32 s27, 10
s_cselect_b32 s10, s40, 0
s_cselect_b32 s14, s38, 0
s_cselect_b32 s18, s39, 0
s_cmp_lt_u32 s30, 1280
s_cselect_b32 s30, s30, 0
s_cselect_b32 s31, s31, 0
s_cselect_b32 s32, s32, 0
s_waitcnt vmcnt(5)
s_barrier
s_add_u32 s3, s29, s41
s_add_u32 m0, s3, 0
s_add_u32 s4, s30, 0
buffer_load_dwordx4 v2, s[8:11], s4 offen lds
s_add_u32 s3, s29, s41
s_add_u32 m0, s3, 1024
s_add_u32 s4, s30, 10240
buffer_load_dwordx4 v3, s[8:11], s4 offen lds
s_add_u32 s3, s29, s42
s_add_u32 m0, s3, 0
s_nop 0
buffer_load_dwordx4 v4, s[12:15], s31 offen lds
s_add_u32 s3, s29, s42
s_add_u32 m0, s3, 1024
s_nop 0
buffer_load_dwordx4 v5, s[12:15], s31 offen lds
s_add_u32 s3, s29, s42
s_add_u32 m0, s3, 2048
s_nop 0
buffer_load_dwordx4 v6, s[12:15], s31 offen lds
s_add_u32 s27, s27, 1
s_add_u32 s29, s29, 39936
s_cmp_eq_u32 s29, 159744
s_cselect_b32 s29, 0, s29
s_add_u32 s30, s30, 128
s_add_u32 s31, s31, s35
s_add_u32 s32, s32, s34
s_cmp_lt_u32 s27, 10
s_cselect_b32 s10, s40, 0
s_cselect_b32 s14, s38, 0
s_cselect_b32 s18, s39, 0
s_cmp_lt_u32 s30, 1280
s_cselect_b32 s30, s30, 0
s_cselect_b32 s31, s31, 0
s_cselect_b32 s32, s32, 0
s_mov_b32 s61, 0
.p2align 3
K1_PL0:
s_add_u32 s3, s29, s41
s_add_u32 m0, s3, 0
s_add_u32 s4, s30, 0
buffer_load_dwordx4 v2, s[8:11], s4 offen lds
s_add_u32 s3, s29, s41
s_add_u32 m0, s3, 1024
s_add_u32 s4, s30, 10240
buffer_load_dwordx4 v3, s[8:11], s4 offen lds
s_add_u32 s3, s29, s42
s_add_u32 m0, s3, 0
s_nop 0
buffer_load_dwordx4 v4, s[12:15], s31 offen lds
s_add_u32 s3, s29, s42
s_add_u32 m0, s3, 1024
s_nop 0
buffer_load_dwordx4 v5, s[12:15], s31 offen lds
s_add_u32 s3, s29, s42
s_add_u32 m0, s3, 2048
s_nop 0
buffer_load_dwordx4 v6, s[12:15], s31 offen lds
s_add_u32 s27, s27, 1
s_add_u32 s29, s29, 39936
s_cmp_eq_u32 s29, 159744
s_cselect_b32 s29, 0, s29
s_add_u32 s30, s30, 128
s_add_u32 s31, s31, s35
s_add_u32 s32, s32, s34
s_cmp_lt_u32 s27, 10
s_cselect_b32 s10, s40, 0
s_cselect_b32 s14, s38, 0
s_cselect_b32 s18, s39, 0
s_cmp_lt_u32 s30, 1280
s_cselect_b32 s30, s30, 0
s_cselect_b32 s31, s31, 0
s_cselect_b32 s32, s32, 0
s_waitcnt vmcnt(10)
s_barrier
s_add_u32 s61, s61, 1
s_cmp_lt_u32 s61, 10
s_cbranch_scc1 K1_PL0
s_waitcnt vmcnt(0)
s_barrier
s_barrier
s_endpgm
K1_PROD1:
s_add_u32 s3, s29, s41
s_add_u32 m0, s3, 0
s_add_u32 s4, s30, 0
buffer_load_dwordx4 v2, s[8:11], s4 offen lds
s_add_u32 s3, s29, s41
s_add_u32 m0, s3, 1024
s_add_u32 s4, s30, 10240
buffer_load_dwordx4 v3, s[8:11], s4 offen lds
s_add_u32 s3, s29, s42
s_add_u32 m0, s3, 0
s_nop 0
buffer_load_dwordx4 v4, s[12:15], s31 offen lds
s_add_u32 s3, s29, s42
s_add_u32 m0, s3, 1024
s_nop 0
buffer_load_dwordx4 v5, s[12:15], s31 offen lds
s_add_u32 m0, s29, s43
s_mov_b64 exec, s[36:37]
buffer_load_dwordx4 v9, s[16:19], s32 offen lds
s_mov_b64 exec, -1
s_add_u32 s27, s27, 1
s_add_u32 s29, s29, 39936
s_cmp_eq_u32 s29, 159744
s_cselect_b32 s29, 0, s29
s_add_u32 s30, s30, 128
s_add_u32 s31, s31, s35
s_add_u32 s32, s32, s34
s_cmp_lt_u32 s27, 10
s_cselect_b32 s10, s40, 0
s_cselect_b32 s14, s38, 0
s_cselect_b32 s18, s39, 0
s_cmp_lt_u32 s30, 1280
s_cselect_b32 s30, s30, 0
s_cselect_b32 s31, s31, 0
s_cselect_b32 s32, s32, 0
s_add_u32 s3, s29, s41
s_add_u32 m0, s3, 0
s_add_u32 s4, s30, 0
buffer_load_dwordx4 v2, s[8:11], s4 offen lds
s_add_u32 s3, s29, s41
s_add_u32 m0, s3, 1024
s_add_u32 s4, s30, 10240
buffer_load_dwordx4 v3, s[8:11], s4 offen lds
s_add_u32 s3, s29, s42
s_add_u32 m0, s3, 0
s_nop 0
buffer_load_dwordx4 v4, s[12:15], s31 offen lds
s_add_u32 s3, s29, s42
s_add_u32 m0, s3, 1024
s_nop 0
buffer_load_dwordx4 v5, s[12:15], s31 offen lds
s_add_u32 m0, s29, s43
s_mov_b64 exec, s[36:37]
buffer_load_dwordx4 v9, s[16:19], s32 offen lds
s_mov_b64 exec, -1
s_add_u32 s27, s27, 1
s_add_u32 s29, s29, 39936
s_cmp_eq_u32 s29, 159744
s_cselect_b32 s29, 0, s29
s_add_u32 s30, s30, 128
s_add_u32 s31, s31, s35
s_add_u32 s32, s32, s34
s_cmp_lt_u32 s27, 10
s_cselect_b32 s10, s40, 0
s_cselect_b32 s14, s38, 0
s_cselect_b32 s18, s39, 0
s_cmp_lt_u32 s30, 1280
s_cselect_b32 s30, s30, 0
s_cselect_b32 s31, s31, 0
s_cselect_b32 s32, s32, 0
s_waitcnt vmcnt(5)
s_barrier
s_add_u32 s3, s29, s41
s_add_u32 m0, s3, 0
s_add_u32 s4, s30, 0
buffer_load_dwordx4 v2, s[8:11], s4 offen lds
s_add_u32 s3, s29, s41
s_add_u32 m0, s3, 1024
s_add_u32 s4, s30, 10240
buffer_load_dwordx4 v3, s[8:11], s4 offen lds
s_add_u32 s3, s29, s42
s_add_u32 m0, s3, 0
s_nop 0
buffer_load_dwordx4 v4, s[12:15], s31 offen lds
s_add_u32 s3, s29, s42
s_add_u32 m0, s3, 1024
s_nop 0
buffer_load_dwordx4 v5, s[12:15], s31 offen lds
s_add_u32 m0, s29, s43
s_mov_b64 exec, s[36:37]
buffer_load_dwordx4 v9, s[16:19], s32 offen lds
s_mov_b64 exec, -1
s_add_u32 s27, s27, 1
s_add_u32 s29, s29, 39936
s_cmp_eq_u32 s29, 159744
s_cselect_b32 s29, 0, s29
s_add_u32 s30, s30, 128
s_add_u32 s31, s31, s35
s_add_u32 s32, s32, s34
s_cmp_lt_u32 s27, 10
s_cselect_b32 s10, s40, 0
s_cselect_b32 s14, s38, 0
s_cselect_b32 s18, s39, 0
s_cmp_lt_u32 s30, 1280
s_cselect_b32 s30, s30, 0
s_cselect_b32 s31, s31, 0
s_cselect_b32 s32, s32, 0
s_mov_b32 s61, 0
.p2align 3
K1_PL1:
s_add_u32 s3, s29, s41
s_add_u32 m0, s3, 0
s_add_u32 s4, s30, 0
buffer_load_dwordx4 v2, s[8:11], s4 offen lds
s_add_u32 s3, s29, s41
s_add_u32 m0, s3, 1024
s_add_u32 s4, s30, 10240
buffer_load_dwordx4 v3, s[8:11], s4 offen lds
s_add_u32 s3, s29, s42
s_add_u32 m0, s3, 0
s_nop 0
buffer_load_dwordx4 v4, s[12:15], s31 offen lds
s_add_u32 s3, s29, s42
s_add_u32 m0, s3, 1024
s_nop 0
buffer_load_dwordx4 v5, s[12:15], s31 offen lds
s_add_u32 m0, s29, s43
s_mov_b64 exec, s[36:37]
buffer_load_dwordx4 v9, s[16:19], s32 offen lds
s_mov_b64 exec, -1
s_add_u32 s27, s27, 1
s_add_u32 s29, s29, 39936
s_cmp_eq_u32 s29, 159744
s_cselect_b32 s29, 0, s29
s_add_u32 s30, s30, 128
s_add_u32 s31, s31, s35
s_add_u32 s32, s32, s34
s_cmp_lt_u32 s27, 10
s_cselect_b32 s10, s40, 0
s_cselect_b32 s14, s38, 0
s_cselect_b32 s18, s39, 0
s_cmp_lt_u32 s30, 1280
s_cselect_b32 s30, s30, 0
s_cselect_b32 s31, s31, 0
s_cselect_b32 s32, s32, 0
s_waitcnt vmcnt(10)
s_barrier
s_add_u32 s61, s61, 1
s_cmp_lt_u32 s61, 10
s_cbranch_scc1 K1_PL1
s_waitcnt vmcnt(0)
s_barrier
s_barrier
s_endpgm
K1_V5:
v_mov_b32 v56, 0
v_mov_b32 v57, 0
v_mov_b32 v58, 0
v_mov_b32 v59, 0
v_mov_b32 v60, 0
v_mov_b32 v61, 0
v_mov_b32 v62, 0
v_mov_b32 v63, 0
v_mov_b32 v64, 0
v_mov_b32 v65, 0
v_mov_b32 v66, 0
v_mov_b32 v67, 0
v_mov_b32 v68, 0
v_mov_b32 v69, 0
v_mov_b32 v70, 0
v_mov_b32 v71, 0
v_mov_b32 v72, 0
v_mov_b32 v73, 0
v_mov_b32 v74, 0
v_mov_b32 v75, 0
v_mov_b32 v76, 0
v_mov_b32 v77, 0
v_mov_b32 v78, 0
v_mov_b32 v79, 0
v_mov_b32 v80, 0
v_mov_b32 v81, 0
v_mov_b32 v82, 0
v_mov_b32 v83, 0
v_mov_b32 v84, 0
v_mov_b32 v85, 0
v_mov_b32 v86, 0
v_mov_b32 v87, 0
v_mov_b32 v88, 0
v_mov_b32 v89, 0
v_mov_b32 v90, 0
v_mov_b32 v91, 0
v_mov_b32 v92, 0
v_mov_b32 v93, 0
v_mov_b32 v94, 0
v_mov_b32 v95, 0
v_mov_b32 v96, 0
v_mov_b32 v97, 0
v_mov_b32 v98, 0
v_mov_b32 v99, 0
v_mov_b32 v100, 0
v_mov_b32 v101, 0
v_mov_b32 v102, 0
v_mov_b32 v103, 0
s_mov_b32 s28, 0
v_add_u32 v16, s28, v10
v_add_u32 v17, s28, v11
v_add_u32 v18, s28, v12
v_add_u32 v19, s28, v13
v_add_u32 v20, s28, v14
s_barrier
ds_read_b128 v[24:27], v16
ds_read_b64_tr_b16 v[32:33], v20 offset:0
ds_read_b64_tr_b16 v[34:35], v20 offset:1280
ds_read_b64_tr_b16 v[36:37], v20 offset:64
ds_read_b64_tr_b16 v[38:39], v20 offset:1344
ds_read_b64_tr_b16 v[40:41], v20 offset:128
ds_read_b64_tr_b16 v[42:43], v20 offset:1408
s_mov_b32 s61, 0
.p2align 3
K1_L5:
s_waitcnt lgkmcnt(0)
v_mfma_f32_32x32x16_bf16 v[56:71], v[32:35], v[24:27], v[56:71]
ds_read_b128 v[28:31], v17
ds_read_b64_tr_b16 v[44:45], v20 offset:5120
ds_read_b64_tr_b16 v[46:47], v20 offset:6400
ds_read_b64_tr_b16 v[48:49], v20 offset:5184
ds_read_b64_tr_b16 v[50:51], v20 offset:6464
ds_read_b64_tr_b16 v[52:53], v20 offset:5248
ds_read_b64_tr_b16 v[54:55], v20 offset:6528
v_mfma_f32_32x32x16_bf16 v[72:87], v[36:39], v[24:27], v[72:87]
v_mfma_f32_32x32x16_bf16 v[88:103], v[40:43], v[24:27], v[88:103]
s_waitcnt lgkmcnt(0)
v_mfma_f32_32x32x16_bf16 v[56:71], v[44:47], v[28:31], v[56:71]
ds_read_b128 v[24:27], v18
ds_read_b64_tr_b16 v[32:33], v20 offset:10240
ds_read_b64_tr_b16 v[34:35], v20 offset:11520
ds_read_b64_tr_b16 v[36:37], v20 offset:10304
ds_read_b64_tr_b16 v[38:39], v20 offset:11584
ds_read_b64_tr_b16 v[40:41], v20 offset:10368
ds_read_b64_tr_b16 v[42:43], v20 offset:11648
v_mfma_f32_32x32x16_bf16 v[72:87], v[48:51], v[28:31], v[72:87]
v_mfma_f32_32x32x16_bf16 v[88:103], v[52:55], v[28:31], v[88:103]
s_waitcnt lgkmcnt(0)
v_mfma_f32_32x32x16_bf16 v[56:71], v[32:35], v[24:27], v[56:71]
ds_read_b128 v[28:31], v19
ds_read_b64_tr_b16 v[44:45], v20 offset:15360
ds_read_b64_tr_b16 v[46:47], v20 offset:16640
ds_read_b64_tr_b16 v[48:49], v20 offset:15424
ds_read_b64_tr_b16 v[50:51], v20 offset:16704
ds_read_b64_tr_b16 v[52:53], v20 offset:15488
ds_read_b64_tr_b16 v[54:55], v20 offset:16768
s_add_u32 s28, s28, 39936
s_cmp_eq_u32 s28, 159744
s_cselect_b32 s28, 0, s28
v_add_u32 v16, s28, v10
v_add_u32 v17, s28, v11
v_add_u32 v18, s28, v12
v_add_u32 v19, s28, v13
v_add_u32 v20, s28, v14
v_mfma_f32_32x32x16_bf16 v[72:87], v[36:39], v[24:27], v[72:87]
v_mfma_f32_32x32x16_bf16 v[88:103], v[40:43], v[24:27], v[88:103]
s_waitcnt lgkmcnt(0)
s_barrier
ds_read_b128 v[24:27], v16
ds_read_b64_tr_b16 v[32:33], v20 offset:0
ds_read_b64_tr_b16 v[34:35], v20 offset:1280
ds_read_b64_tr_b16 v[36:37], v20 offset:64
ds_read_b64_tr_b16 v[38:39], v20 offset:1344
ds_read_b64_tr_b16 v[40:41], v20 offset:128
ds_read_b64_tr_b16 v[42:43], v20 offset:1408
v_mfma_f32_32x32x16_bf16 v[56:71], v[44:47], v[28:31], v[56:71]
v_mfma_f32_32x32x16_bf16 v[72:87], v[48:51], v[28:31], v[72:87]
v_mfma_f32_32x32x16_bf16 v[88:103], v[52:55], v[28:31], v[88:103]
s_add_u32 s61, s61, 1
s_cmp_lt_u32 s61, 10
s_cbranch_scc1 K1_L5
s_waitcnt lgkmcnt(0)
s_nop 7
s_nop 7
s_waitcnt vmcnt(0)
s_barrier
s_cmp_ge_u32 s25, 8
s_cbranch_scc1 K1_V5K
v_and_b32 v104, 31, v0
v_lshrrev_b32 v105, 5, v0
s_lshl_b32 s3, s26, 5
v_add_u32 v106, s3, v104
v_mul_u32_u24 v106, 40, v106
v_lshl_add_u32 v24, v105, 3, v106
v_lshl_add_u32 v25, v105, 3, v106
v_add_u32 v25, 8, v25
v_lshl_add_u32 v26, v105, 3, v106
v_add_u32 v26, 16, v26
v_lshl_add_u32 v27, v105, 3, v106
v_add_u32 v27, 24, v27
v_mul_u32_u24 v107, 5088, v105
v_add3_u32 v28, v106, v107, 32
s_mov_b32 s63, 0x3ea52b5c
v_mul_f32 v56, s63, v56
v_mul_f32 v57, s63, v57
v_mul_f32 v58, s63, v58
v_mul_f32 v59, s63, v59
v_cvt_pk_bf16_f32 v32, v56, v57
v_cvt_pk_bf16_f32 v33, v58, v59
ds_write_b64 v24, v[32:33] offset:0
v_mul_f32 v60, s63, v60
v_mul_f32 v61, s63, v61
v_mul_f32 v62, s63, v62
v_mul_f32 v63, s63, v63
v_cvt_pk_bf16_f32 v34, v60, v61
v_cvt_pk_bf16_f32 v35, v62, v63
ds_write_b64 v26, v[34:35] offset:0
v_mul_f32 v64, s63, v64
v_mul_f32 v65, s63, v65
v_mul_f32 v66, s63, v66
v_mul_f32 v67, s63, v67
v_cvt_pk_bf16_f32 v36, v64, v65
v_cvt_pk_bf16_f32 v37, v66, v67
ds_write_b64 v28, v[36:37] offset:0
v_mul_f32 v68, s63, v68
v_mul_f32 v69, s63, v69
v_mul_f32 v70, s63, v70
v_mul_f32 v71, s63, v71
v_cvt_pk_bf16_f32 v38, v68, v69
v_cvt_pk_bf16_f32 v39, v70, v71
ds_write_b64 v25, v[38:39] offset:5120
v_mul_f32 v72, s63, v72
v_mul_f32 v73, s63, v73
v_mul_f32 v74, s63, v74
v_mul_f32 v75, s63, v75
v_cvt_pk_bf16_f32 v40, v72, v73
v_cvt_pk_bf16_f32 v41, v74, v75
ds_write_b64 v27, v[40:41] offset:5120
v_mul_f32 v76, s63, v76
v_mul_f32 v77, s63, v77
v_mul_f32 v78, s63, v78
v_mul_f32 v79, s63, v79
v_cvt_pk_bf16_f32 v42, v76, v77
v_cvt_pk_bf16_f32 v43, v78, v79
ds_write_b64 v24, v[42:43] offset:10240
v_mul_f32 v80, s63, v80
v_mul_f32 v81, s63, v81
v_mul_f32 v82, s63, v82
v_mul_f32 v83, s63, v83
v_cvt_pk_bf16_f32 v44, v80, v81
v_cvt_pk_bf16_f32 v45, v82, v83
ds_write_b64 v26, v[44:45] offset:10240
v_mul_f32 v84, s63, v84
v_mul_f32 v85, s63, v85
v_mul_f32 v86, s63, v86
v_mul_f32 v87, s63, v87
v_cvt_pk_bf16_f32 v46, v84, v85
v_cvt_pk_bf16_f32 v47, v86, v87
ds_write_b64 v28, v[46:47] offset:10240
v_mul_f32 v88, s63, v88
v_mul_f32 v89, s63, v89
v_mul_f32 v90, s63, v90
v_mul_f32 v91, s63, v91
v_cvt_pk_bf16_f32 v32, v88, v89
v_cvt_pk_bf16_f32 v33, v90, v91
ds_write_b64 v25, v[32:33] offset:15360
v_mul_f32 v92, s63, v92
v_mul_f32 v93, s63, v93
v_mul_f32 v94, s63, v94
v_mul_f32 v95, s63, v95
v_cvt_pk_bf16_f32 v34, v92, v93
v_cvt_pk_bf16_f32 v35, v94, v95
ds_write_b64 v27, v[34:35] offset:15360
v_mul_f32 v96, s63, v96
v_mul_f32 v97, s63, v97
v_mul_f32 v98, s63, v98
v_mul_f32 v99, s63, v99
v_cvt_pk_bf16_f32 v36, v96, v97
v_cvt_pk_bf16_f32 v37, v98, v99
ds_write_b64 v24, v[36:37] offset:20480
v_mul_f32 v100, s63, v100
v_mul_f32 v101, s63, v101
v_mul_f32 v102, s63, v102
v_mul_f32 v103, s63, v103
v_cvt_pk_bf16_f32 v38, v100, v101
v_cvt_pk_bf16_f32 v39, v102, v103
ds_write_b64 v26, v[38:39] offset:20480
s_waitcnt lgkmcnt(0)
s_barrier
s_mul_i32 s3, s65, 5120
v_lshlrev_b32 v104, 4, v0
v_add_u32 v105, s3, v104
ds_read_b128 v[32:35], v105 offset:0
ds_read_b128 v[36:39], v105 offset:1024
ds_read_b128 v[40:43], v105 offset:2048
ds_read_b128 v[44:47], v105 offset:3072
ds_read_b128 v[48:51], v105 offset:4096
s_and_b32 s3, s25, 3
s_lshl_b32 s3, s3, 3
s_add_u32 s3, s3, s65
s_mul_i32 s3, s3, 81920
s_cmp_lt_u32 s25, 4
s_cselect_b32 s4, 0, 2621440
s_add_u32 s62, s3, s4
s_mul_i32 s4, s24, 5120
s_add_u32 s62, s62, s4
s_waitcnt lgkmcnt(4)
buffer_store_dwordx4 v[32:35], v104, s[20:23], s62 offen offset:0 sc0 sc1
s_waitcnt lgkmcnt(3)
buffer_store_dwordx4 v[36:39], v104, s[20:23], s62 offen offset:1024 sc0 sc1
s_waitcnt lgkmcnt(2)
buffer_store_dwordx4 v[40:43], v104, s[20:23], s62 offen offset:2048 sc0 sc1
s_waitcnt lgkmcnt(1)
buffer_store_dwordx4 v[44:47], v104, s[20:23], s62 offen offset:3072 sc0 sc1
s_add_u32 s62, s62, 4096
s_waitcnt lgkmcnt(0)
buffer_store_dwordx4 v[48:51], v104, s[20:23], s62 offen sc0 sc1
s_endpgm
K1_V5K:
v_and_b32 v104, 31, v0
v_lshrrev_b32 v105, 5, v0
s_mul_i32 s3, s26, 1280
v_lshlrev_b32 v106, 4, v104
v_add_u32 v106, s3, v106
v_lshlrev_b32 v107, 3, v104
v_add_u32 v107, 1024, v107
v_add_u32 v107, s3, v107
v_lshl_add_u32 v24, v105, 3, v106
v_mul_u32_u24 v108, 504, v105
v_add3_u32 v25, v106, v108, 8
v_add_u32 v26, 512, v24
v_cmp_eq_u32 vcc, 0, v105
v_add_u32 v108, 520, v106
s_nop 0
v_cndmask_b32 v27, v107, v108, vcc
v_add_u32 v108, 5120, v106
v_cndmask_b32 v28, v108, v107, vcc
v_cvt_pk_bf16_f32 v32, v56, v57
v_cvt_pk_bf16_f32 v33, v58, v59
ds_write_b64 v24, v[32:33] offset:0
v_cvt_pk_bf16_f32 v34, v60, v61
v_cvt_pk_bf16_f32 v35, v62, v63
ds_write_b64 v26, v[34:35] offset:0
v_cvt_pk_bf16_f32 v36, v64, v65
v_cvt_pk_bf16_f32 v37, v66, v67
ds_write_b64 v28, v[36:37] offset:0
v_cvt_pk_bf16_f32 v38, v68, v69
v_cvt_pk_bf16_f32 v39, v70, v71
ds_write_b64 v25, v[38:39] offset:5120
v_cvt_pk_bf16_f32 v40, v72, v73
v_cvt_pk_bf16_f32 v41, v74, v75
ds_write_b64 v27, v[40:41] offset:5120
v_cvt_pk_bf16_f32 v42, v76, v77
v_cvt_pk_bf16_f32 v43, v78, v79
ds_write_b64 v24, v[42:43] offset:10240
v_cvt_pk_bf16_f32 v44, v80, v81
v_cvt_pk_bf16_f32 v45, v82, v83
ds_write_b64 v26, v[44:45] offset:10240
v_cvt_pk_bf16_f32 v46, v84, v85
v_cvt_pk_bf16_f32 v47, v86, v87
ds_write_b64 v28, v[46:47] offset:10240
v_cvt_pk_bf16_f32 v32, v88, v89
v_cvt_pk_bf16_f32 v33, v90, v91
ds_write_b64 v25, v[32:33] offset:15360
v_cvt_pk_bf16_f32 v34, v92, v93
v_cvt_pk_bf16_f32 v35, v94, v95
ds_write_b64 v27, v[34:35] offset:15360
v_cvt_pk_bf16_f32 v36, v96, v97
v_cvt_pk_bf16_f32 v37, v98, v99
ds_write_b64 v24, v[36:37] offset:20480
v_cvt_pk_bf16_f32 v38, v100, v101
v_cvt_pk_bf16_f32 v39, v102, v103
ds_write_b64 v26, v[38:39] offset:20480
s_waitcnt lgkmcnt(0)
s_barrier
s_mul_i32 s3, s65, 5120
v_lshlrev_b32 v104, 4, v0
v_add_u32 v105, s3, v104
ds_read_b128 v[32:35], v105 offset:0
ds_read_b128 v[36:39], v105 offset:1024
ds_read_b128 v[40:43], v105 offset:2048
ds_read_b128 v[44:47], v105 offset:3072
ds_read_b128 v[48:51], v105 offset:4096
s_and_b32 s3, s25, 3
s_lshl_b32 s3, s3, 3
s_add_u32 s3, s3, s65
s_mul_i32 s3, s3, 196608
s_mul_i32 s4, s24, 12288
s_add_u32 s62, s3, s4
s_add_u32 s62, s62, 5439488
v_add_u32 v106, 0, v0
v_mul_u32_u24 v107, 52429, v106
v_lshrrev_b32 v107, 22, v107
v_mul_u32_u24 v107, 1792, v107
v_lshl_add_u32 v24, v106, 4, v107
v_add_u32 v106, 64, v0
v_mul_u32_u24 v107, 52429, v106
v_lshrrev_b32 v107, 22, v107
v_mul_u32_u24 v107, 1792, v107
v_lshl_add_u32 v25, v106, 4, v107
v_add_u32 v106, 128, v0
v_mul_u32_u24 v107, 52429, v106
v_lshrrev_b32 v107, 22, v107
v_mul_u32_u24 v107, 1792, v107
v_lshl_add_u32 v26, v106, 4, v107
v_add_u32 v106, 192, v0
v_mul_u32_u24 v107, 52429, v106
v_lshrrev_b32 v107, 22, v107
v_mul_u32_u24 v107, 1792, v107
v_lshl_add_u32 v27, v106, 4, v107
v_add_u32 v106, 256, v0
v_mul_u32_u24 v107, 52429, v106
v_lshrrev_b32 v107, 22, v107
v_mul_u32_u24 v107, 1792, v107
v_lshl_add_u32 v28, v106, 4, v107
s_waitcnt lgkmcnt(4)
buffer_store_dwordx4 v[32:35], v24, s[20:23], s62 offen sc0 sc1
s_waitcnt lgkmcnt(3)
buffer_store_dwordx4 v[36:39], v25, s[20:23], s62 offen sc0 sc1
s_waitcnt lgkmcnt(2)
buffer_store_dwordx4 v[40:43], v26, s[20:23], s62 offen sc0 sc1
s_waitcnt lgkmcnt(1)
buffer_store_dwordx4 v[44:47], v27, s[20:23], s62 offen sc0 sc1
s_waitcnt lgkmcnt(0)
buffer_store_dwordx4 v[48:51], v28, s[20:23], s62 offen sc0 sc1
s_endpgm
K1_V6:
v_mov_b32 v56, 0
v_mov_b32 v57, 0
v_mov_b32 v58, 0
v_mov_b32 v59, 0
v_mov_b32 v60, 0
v_mov_b32 v61, 0
v_mov_b32 v62, 0
v_mov_b32 v63, 0
v_mov_b32 v64, 0
v_mov_b32 v65, 0
v_mov_b32 v66, 0
v_mov_b32 v67, 0
v_mov_b32 v68, 0
v_mov_b32 v69, 0
v_mov_b32 v70, 0
v_mov_b32 v71, 0
v_mov_b32 v72, 0
v_mov_b32 v73, 0
v_mov_b32 v74, 0
v_mov_b32 v75, 0
v_mov_b32 v76, 0
v_mov_b32 v77, 0
v_mov_b32 v78, 0
v_mov_b32 v79, 0
v_mov_b32 v80, 0
v_mov_b32 v81, 0
v_mov_b32 v82, 0
v_mov_b32 v83, 0
v_mov_b32 v84, 0
v_mov_b32 v85, 0
v_mov_b32 v86, 0
v_mov_b32 v87, 0
v_mov_b32 v88, 0
v_mov_b32 v89, 0
v_mov_b32 v90, 0
v_mov_b32 v91, 0
v_mov_b32 v92, 0
v_mov_b32 v93, 0
v_mov_b32 v94, 0
v_mov_b32 v95, 0
v_mov_b32 v96, 0
v_mov_b32 v97, 0
v_mov_b32 v98, 0
v_mov_b32 v99, 0
v_mov_b32 v100, 0
v_mov_b32 v101, 0
v_mov_b32 v102, 0
v_mov_b32 v103, 0
s_mov_b32 s28, 0
v_add_u32 v16, s28, v10
v_add_u32 v17, s28, v11
v_add_u32 v18, s28, v12
v_add_u32 v19, s28, v13
v_add_u32 v20, s28, v14
s_barrier
ds_read_b128 v[24:27], v16
ds_read_b64_tr_b16 v[32:33], v20 offset:0
ds_read_b64_tr_b16 v[34:35], v20 offset:1280
ds_read_b64_tr_b16 v[36:37], v20 offset:64
ds_read_b64_tr_b16 v[38:39], v20 offset:1344
ds_read_b64_tr_b16 v[40:41], v20 offset:128
ds_read_b64_tr_b16 v[42:43], v20 offset:1408
s_mov_b32 s61, 0
.p2align 3
K1_L6:
s_waitcnt lgkmcnt(0)
v_mfma_f32_32x32x16_bf16 v[56:71], v[24:27], v[32:35], v[56:71]
ds_read_b128 v[28:31], v17
ds_read_b64_tr_b16 v[44:45], v20 offset:5120
ds_read_b64_tr_b16 v[46:47], v20 offset:6400
ds_read_b64_tr_b16 v[48:49], v20 offset:5184
ds_read_b64_tr_b16 v[50:51], v20 offset:6464
ds_read_b64_tr_b16 v[52:53], v20 offset:5248
ds_read_b64_tr_b16 v[54:55], v20 offset:6528
v_mfma_f32_32x32x16_bf16 v[72:87], v[24:27], v[36:39], v[72:87]
v_mfma_f32_32x32x16_bf16 v[88:103], v[24:27], v[40:43], v[88:103]
s_waitcnt lgkmcnt(0)
v_mfma_f32_32x32x16_bf16 v[56:71], v[28:31], v[44:47], v[56:71]
ds_read_b128 v[24:27], v18
ds_read_b64_tr_b16 v[32:33], v20 offset:10240
ds_read_b64_tr_b16 v[34:35], v20 offset:11520
ds_read_b64_tr_b16 v[36:37], v20 offset:10304
ds_read_b64_tr_b16 v[38:39], v20 offset:11584
ds_read_b64_tr_b16 v[40:41], v20 offset:10368
ds_read_b64_tr_b16 v[42:43], v20 offset:11648
v_mfma_f32_32x32x16_bf16 v[72:87], v[28:31], v[48:51], v[72:87]
v_mfma_f32_32x32x16_bf16 v[88:103], v[28:31], v[52:55], v[88:103]
s_waitcnt lgkmcnt(0)
v_mfma_f32_32x32x16_bf16 v[56:71], v[24:27], v[32:35], v[56:71]
ds_read_b128 v[28:31], v19
ds_read_b64_tr_b16 v[44:45], v20 offset:15360
ds_read_b64_tr_b16 v[46:47], v20 offset:16640
ds_read_b64_tr_b16 v[48:49], v20 offset:15424
ds_read_b64_tr_b16 v[50:51], v20 offset:16704
ds_read_b64_tr_b16 v[52:53], v20 offset:15488
ds_read_b64_tr_b16 v[54:55], v20 offset:16768
s_add_u32 s28, s28, 39936
s_cmp_eq_u32 s28, 159744
s_cselect_b32 s28, 0, s28
v_add_u32 v16, s28, v10
v_add_u32 v17, s28, v11
v_add_u32 v18, s28, v12
v_add_u32 v19, s28, v13
v_add_u32 v20, s28, v14
v_mfma_f32_32x32x16_bf16 v[72:87], v[24:27], v[36:39], v[72:87]
v_mfma_f32_32x32x16_bf16 v[88:103], v[24:27], v[40:43], v[88:103]
s_waitcnt lgkmcnt(0)
s_barrier
ds_read_b128 v[24:27], v16
ds_read_b64_tr_b16 v[32:33], v20 offset:0
ds_read_b64_tr_b16 v[34:35], v20 offset:1280
ds_read_b64_tr_b16 v[36:37], v20 offset:64
ds_read_b64_tr_b16 v[38:39], v20 offset:1344
ds_read_b64_tr_b16 v[40:41], v20 offset:128
ds_read_b64_tr_b16 v[42:43], v20 offset:1408
v_mfma_f32_32x32x16_bf16 v[56:71], v[28:31], v[44:47], v[56:71]
v_mfma_f32_32x32x16_bf16 v[72:87], v[28:31], v[48:51], v[72:87]
v_mfma_f32_32x32x16_bf16 v[88:103], v[28:31], v[52:55], v[88:103]
s_add_u32 s61, s61, 1
s_cmp_lt_u32 s61, 10
s_cbranch_scc1 K1_L6
s_waitcnt lgkmcnt(0)
s_nop 7
s_nop 7
s_waitcnt vmcnt(0)
s_barrier
v_and_b32 v104, 31, v0
v_lshrrev_b32 v105, 5, v0
v_mul_u32_u24 v105, 384, v105
s_mul_i32 s3, s26, 1536
v_add_u32 v105, s3, v105
v_add_u32 v106, 0, v104
v_mul_u32_u24 v107, 52429, v106
v_lshrrev_b32 v107, 20, v107
v_mul_u32_u24 v108, 20, v107
v_sub_u32 v108, v106, v108
v_mul_u32_u24 v107, 6144, v107
v_lshl_add_u32 v108, v108, 4, v107
v_add_u32 v24, v108, v105
v_add_u32 v106, 32, v104
v_mul_u32_u24 v107, 52429, v106
v_lshrrev_b32 v107, 20, v107
v_mul_u32_u24 v108, 20, v107
v_sub_u32 v108, v106, v108
v_mul_u32_u24 v107, 6144, v107
v_lshl_add_u32 v108, v108, 4, v107
v_add_u32 v25, v108, v105
v_add_u32 v106, 64, v104
v_mul_u32_u24 v107, 52429, v106
v_lshrrev_b32 v107, 20, v107
v_mul_u32_u24 v108, 20, v107
v_sub_u32 v108, v106, v108
v_mul_u32_u24 v107, 6144, v107
v_lshl_add_u32 v108, v108, 4, v107
v_add_u32 v26, v108, v105
v_cvt_pk_bf16_f32 v32, v56, v57
v_cvt_pk_bf16_f32 v33, v58, v59
v_cvt_pk_bf16_f32 v34, v60, v61
v_cvt_pk_bf16_f32 v35, v62, v63
ds_write_b128 v24, v[32:35] offset:0
v_cvt_pk_bf16_f32 v36, v64, v65
v_cvt_pk_bf16_f32 v37, v66, v67
v_cvt_pk_bf16_f32 v38, v68, v69
v_cvt_pk_bf16_f32 v39, v70, v71
ds_write_b128 v24, v[36:39] offset:768
v_cvt_pk_bf16_f32 v40, v72, v73
v_cvt_pk_bf16_f32 v41, v74, v75
v_cvt_pk_bf16_f32 v42, v76, v77
v_cvt_pk_bf16_f32 v43, v78, v79
ds_write_b128 v25, v[40:43] offset:0
v_cvt_pk_bf16_f32 v44, v80, v81
v_cvt_pk_bf16_f32 v45, v82, v83
v_cvt_pk_bf16_f32 v46, v84, v85
v_cvt_pk_bf16_f32 v47, v86, v87
ds_write_b128 v25, v[44:47] offset:768
v_cvt_pk_bf16_f32 v48, v88, v89
v_cvt_pk_bf16_f32 v49, v90, v91
v_cvt_pk_bf16_f32 v50, v92, v93
v_cvt_pk_bf16_f32 v51, v94, v95
ds_write_b128 v26, v[48:51] offset:0
v_cvt_pk_bf16_f32 v52, v96, v97
v_cvt_pk_bf16_f32 v53, v98, v99
v_cvt_pk_bf16_f32 v54, v100, v101
v_cvt_pk_bf16_f32 v55, v102, v103
ds_write_b128 v26, v[52:55] offset:768
s_waitcnt lgkmcnt(0)
s_barrier
s_mul_i32 s3, s65, 6144
v_lshlrev_b32 v104, 4, v0
v_add_u32 v105, s3, v104
ds_read_b128 v[32:35], v105 offset:0
ds_read_b128 v[36:39], v105 offset:1024
ds_read_b128 v[40:43], v105 offset:2048
ds_read_b128 v[44:47], v105 offset:3072
ds_read_b128 v[48:51], v105 offset:4096
ds_read_b128 v[52:55], v105 offset:5120
s_and_b32 s3, s25, 3
s_lshl_b32 s3, s3, 3
s_add_u32 s3, s3, s65
s_mul_i32 s3, s3, 196608
s_mul_i32 s4, s24, 12288
s_add_u32 s62, s3, s4
s_add_u32 s62, s62, 5441024
v_add_u32 v106, 0, v0
v_mul_u32_u24 v107, 43691, v106
v_lshrrev_b32 v107, 22, v107
v_mul_u32_u24 v107, 1536, v107
v_lshl_add_u32 v24, v106, 4, v107
v_add_u32 v106, 64, v0
v_mul_u32_u24 v107, 43691, v106
v_lshrrev_b32 v107, 22, v107
v_mul_u32_u24 v107, 1536, v107
v_lshl_add_u32 v25, v106, 4, v107
v_add_u32 v106, 128, v0
v_mul_u32_u24 v107, 43691, v106
v_lshrrev_b32 v107, 22, v107
v_mul_u32_u24 v107, 1536, v107
v_lshl_add_u32 v26, v106, 4, v107
v_add_u32 v106, 192, v0
v_mul_u32_u24 v107, 43691, v106
v_lshrrev_b32 v107, 22, v107
v_mul_u32_u24 v107, 1536, v107
v_lshl_add_u32 v27, v106, 4, v107
v_add_u32 v106, 256, v0
v_mul_u32_u24 v107, 43691, v106
v_lshrrev_b32 v107, 22, v107
v_mul_u32_u24 v107, 1536, v107
v_lshl_add_u32 v28, v106, 4, v107
v_add_u32 v106, 320, v0
v_mul_u32_u24 v107, 43691, v106
v_lshrrev_b32 v107, 22, v107
v_mul_u32_u24 v107, 1536, v107
v_lshl_add_u32 v29, v106, 4, v107
s_waitcnt lgkmcnt(5)
buffer_store_dwordx4 v[32:35], v24, s[20:23], s62 offen sc0 sc1
s_waitcnt lgkmcnt(4)
buffer_store_dwordx4 v[36:39], v25, s[20:23], s62 offen sc0 sc1
s_waitcnt lgkmcnt(3)
buffer_store_dwordx4 v[40:43], v26, s[20:23], s62 offen sc0 sc1
s_waitcnt lgkmcnt(2)
buffer_store_dwordx4 v[44:47], v27, s[20:23], s62 offen sc0 sc1
s_waitcnt lgkmcnt(1)
buffer_store_dwordx4 v[48:51], v28, s[20:23], s62 offen sc0 sc1
s_waitcnt lgkmcnt(0)
buffer_store_dwordx4 v[52:55], v29, s[20:23], s62 offen sc0 sc1
s_endpgm
K1_V0:
v_mov_b32 v56, 0
v_mov_b32 v57, 0
v_mov_b32 v58, 0
v_mov_b32 v59, 0
v_mov_b32 v60, 0
v_mov_b32 v61, 0
v_mov_b32 v62, 0
v_mov_b32 v63, 0
v_mov_b32 v64, 0
v_mov_b32 v65, 0
v_mov_b32 v66, 0
v_mov_b32 v67, 0
v_mov_b32 v68, 0
v_mov_b32 v69, 0
v_mov_b32 v70, 0
v_mov_b32 v71, 0
v_mov_b32 v72, 0
v_mov_b32 v73, 0
v_mov_b32 v74, 0
v_mov_b32 v75, 0
v_mov_b32 v76, 0
v_mov_b32 v77, 0
v_mov_b32 v78, 0
v_mov_b32 v79, 0
v_mov_b32 v80, 0
v_mov_b32 v81, 0
v_mov_b32 v82, 0
v_mov_b32 v83, 0
v_mov_b32 v84, 0
v_mov_b32 v85, 0
v_mov_b32 v86, 0
v_mov_b32 v87, 0
v_mov_b32 v88, 0
v_mov_b32 v89, 0
v_mov_b32 v90, 0
v_mov_b32 v91, 0
v_mov_b32 v92, 0
v_mov_b32 v93, 0
v_mov_b32 v94, 0
v_mov_b32 v95, 0
v_mov_b32 v96, 0
v_mov_b32 v97, 0
v_mov_b32 v98, 0
v_mov_b32 v99, 0
v_mov_b32 v100, 0
v_mov_b32 v101, 0
v_mov_b32 v102, 0
v_mov_b32 v103, 0
s_mov_b32 s28, 0
v_add_u32 v16, s28, v10
v_add_u32 v17, s28, v11
v_add_u32 v18, s28, v12
v_add_u32 v19, s28, v13
v_add_u32 v20, s28, v14
v_add_u32 v21, s28, v15
v_add_u32 v23, s28, v22
s_barrier
ds_read_b128 v[24:27], v16
ds_read_b64_tr_b16 v[32:33], v20 offset:192
ds_read_b64_tr_b16 v[34:35], v20 offset:1472
ds_read_b64_tr_b16 v[36:37], v20 offset:256
ds_read_b64_tr_b16 v[38:39], v20 offset:1536
s_mov_b32 s61, 0
.p2align 3
K1_L0:
s_waitcnt lgkmcnt(0)
v_mfma_f32_32x32x16_bf16 v[56:71], v[32:35], v[24:27], v[56:71]
ds_read_b128 v[28:31], v17
ds_read_b64_tr_b16 v[44:45], v20 offset:5312
ds_read_b64_tr_b16 v[46:47], v20 offset:6592
ds_read_b64_tr_b16 v[48:49], v20 offset:5376
ds_read_b64_tr_b16 v[50:51], v20 offset:6656
ds_read_b128 v[52:55], v23
ds_read_b64_tr_b16 v[40:41], v21 offset:0
ds_read_b64_tr_b16 v[42:43], v21 offset:160
v_mfma_f32_32x32x16_bf16 v[72:87], v[36:39], v[24:27], v[72:87]
s_waitcnt lgkmcnt(0)
v_mfma_f32_32x32x16_bf16 v[56:71], v[44:47], v[28:31], v[56:71]
ds_read_b128 v[24:27], v18
ds_read_b64_tr_b16 v[32:33], v20 offset:10432
ds_read_b64_tr_b16 v[34:35], v20 offset:11712
ds_read_b64_tr_b16 v[36:37], v20 offset:10496
ds_read_b64_tr_b16 v[38:39], v20 offset:11776
v_mfma_f32_32x32x16_bf16 v[72:87], v[48:51], v[28:31], v[72:87]
v_mfma_f32_32x32x16_bf16 v[88:103], v[40:43], v[52:55], v[88:103]
s_waitcnt lgkmcnt(0)
v_mfma_f32_32x32x16_bf16 v[56:71], v[32:35], v[24:27], v[56:71]
ds_read_b128 v[28:31], v19
ds_read_b64_tr_b16 v[44:45], v20 offset:15552
ds_read_b64_tr_b16 v[46:47], v20 offset:16832
ds_read_b64_tr_b16 v[48:49], v20 offset:15616
ds_read_b64_tr_b16 v[50:51], v20 offset:16896
s_add_u32 s28, s28, 39936
s_cmp_eq_u32 s28, 159744
s_cselect_b32 s28, 0, s28
v_add_u32 v16, s28, v10
v_add_u32 v17, s28, v11
v_add_u32 v18, s28, v12
v_add_u32 v19, s28, v13
v_add_u32 v20, s28, v14
v_add_u32 v21, s28, v15
v_add_u32 v23, s28, v22
v_mfma_f32_32x32x16_bf16 v[72:87], v[36:39], v[24:27], v[72:87]
s_waitcnt lgkmcnt(0)
s_barrier
ds_read_b128 v[24:27], v16
ds_read_b64_tr_b16 v[32:33], v20 offset:192
ds_read_b64_tr_b16 v[34:35], v20 offset:1472
ds_read_b64_tr_b16 v[36:37], v20 offset:256
ds_read_b64_tr_b16 v[38:39], v20 offset:1536
v_mfma_f32_32x32x16_bf16 v[56:71], v[44:47], v[28:31], v[56:71]
v_mfma_f32_32x32x16_bf16 v[72:87], v[48:51], v[28:31], v[72:87]
s_add_u32 s61, s61, 1
s_cmp_lt_u32 s61, 10
s_cbranch_scc1 K1_L0
s_waitcnt lgkmcnt(0)
s_nop 7
s_nop 7
s_waitcnt vmcnt(0)
s_barrier
s_lshl_b32 s3, s26, 12
s_add_u32 s3, s3, 40960
v_lshlrev_b32 v104, 4, v0
v_add_u32 v113, s3, v104
ds_write_b128 v113, v[88:91] offset:0
ds_write_b128 v113, v[92:95] offset:1024
ds_write_b128 v113, v[96:99] offset:2048
ds_write_b128 v113, v[100:103] offset:3072
v_and_b32 v104, 31, v0
v_lshrrev_b32 v105, 5, v0
s_lshl_b32 s3, s26, 5
v_add_u32 v106, s3, v104
v_mul_u32_u24 v106, 40, v106
v_lshl_add_u32 v24, v105, 3, v106
v_lshl_add_u32 v25, v105, 3, v106
v_add_u32 v25, 8, v25
v_lshl_add_u32 v26, v105, 3, v106
v_add_u32 v26, 16, v26
v_lshl_add_u32 v27, v105, 3, v106
v_add_u32 v27, 24, v27
v_mul_u32_u24 v107, 5088, v105
v_add3_u32 v28, v106, v107, 32
s_mov_b32 s63, 0x3ea52b5c
v_mul_f32 v56, s63, v56
v_mul_f32 v57, s63, v57
v_mul_f32 v58, s63, v58
v_mul_f32 v59, s63, v59
v_cvt_pk_bf16_f32 v32, v56, v57
v_cvt_pk_bf16_f32 v33, v58, v59
ds_write_b64 v28, v[32:33] offset:20480
v_mul_f32 v60, s63, v60
v_mul_f32 v61, s63, v61
v_mul_f32 v62, s63, v62
v_mul_f32 v63, s63, v63
v_cvt_pk_bf16_f32 v34, v60, v61
v_cvt_pk_bf16_f32 v35, v62, v63
ds_write_b64 v25, v[34:35] offset:25600
v_mul_f32 v64, s63, v64
v_mul_f32 v65, s63, v65
v_mul_f32 v66, s63, v66
v_mul_f32 v67, s63, v67
v_cvt_pk_bf16_f32 v36, v64, v65
v_cvt_pk_bf16_f32 v37, v66, v67
ds_write_b64 v27, v[36:37] offset:25600
v_mul_f32 v68, s63, v68
v_mul_f32 v69, s63, v69
v_mul_f32 v70, s63, v70
v_mul_f32 v71, s63, v71
v_cvt_pk_bf16_f32 v38, v68, v69
v_cvt_pk_bf16_f32 v39, v70, v71
ds_write_b64 v24, v[38:39] offset:30720
v_mul_f32 v72, s63, v72
v_mul_f32 v73, s63, v73
v_mul_f32 v74, s63, v74
v_mul_f32 v75, s63, v75
v_cvt_pk_bf16_f32 v40, v72, v73
v_cvt_pk_bf16_f32 v41, v74, v75
ds_write_b64 v26, v[40:41] offset:30720
v_mul_f32 v76, s63, v76
v_mul_f32 v77, s63, v77
v_mul_f32 v78, s63, v78
v_mul_f32 v79, s63, v79
v_cvt_pk_bf16_f32 v42, v76, v77
v_cvt_pk_bf16_f32 v43, v78, v79
ds_write_b64 v28, v[42:43] offset:30720
v_mul_f32 v80, s63, v80
v_mul_f32 v81, s63, v81
v_mul_f32 v82, s63, v82
v_mul_f32 v83, s63, v83
v_cvt_pk_bf16_f32 v44, v80, v81
v_cvt_pk_bf16_f32 v45, v82, v83
ds_write_b64 v25, v[44:45] offset:35840
v_mul_f32 v84, s63, v84
v_mul_f32 v85, s63, v85
v_mul_f32 v86, s63, v86
v_mul_f32 v87, s63, v87
v_cvt_pk_bf16_f32 v46, v84, v85
v_cvt_pk_bf16_f32 v47, v86, v87
ds_write_b64 v27, v[46:47] offset:35840
s_waitcnt lgkmcnt(0)
s_barrier
s_mul_i32 s3, s65, 5120
v_lshlrev_b32 v104, 4, v0
v_add_u32 v105, s3, v104
ds_read_b128 v[32:35], v105 offset:0
ds_read_b128 v[36:39], v105 offset:1024
ds_read_b128 v[40:43], v105 offset:2048
ds_read_b128 v[44:47], v105 offset:3072
ds_read_b128 v[48:51], v105 offset:4096
s_and_b32 s3, s25, 3
s_lshl_b32 s3, s3, 3
s_add_u32 s3, s3, s65
s_mul_i32 s3, s3, 81920
s_cmp_lt_u32 s25, 4
s_cselect_b32 s4, 0, 2621440
s_add_u32 s62, s3, s4
s_mul_i32 s4, s24, 5120
s_add_u32 s62, s62, s4
s_waitcnt lgkmcnt(4)
buffer_store_dwordx4 v[32:35], v104, s[20:23], s62 offen offset:0 sc0 sc1
s_waitcnt lgkmcnt(3)
buffer_store_dwordx4 v[36:39], v104, s[20:23], s62 offen offset:1024 sc0 sc1
s_waitcnt lgkmcnt(2)
buffer_store_dwordx4 v[40:43], v104, s[20:23], s62 offen offset:2048 sc0 sc1
s_waitcnt lgkmcnt(1)
buffer_store_dwordx4 v[44:47], v104, s[20:23], s62 offen offset:3072 sc0 sc1
s_add_u32 s62, s62, 4096
s_waitcnt lgkmcnt(0)
buffer_store_dwordx4 v[48:51], v104, s[20:23], s62 offen sc0 sc1
s_cmp_eq_u32 s26, 0
s_cbranch_scc0 K1_XE0
ds_read_b128 v[56:59], v113 offset:4096
ds_read_b128 v[60:63], v113 offset:5120
ds_read_b128 v[64:67], v113 offset:6144
ds_read_b128 v[68:71], v113 offset:7168
s_waitcnt lgkmcnt(0)
v_add_f32 v88, v88, v56
v_add_f32 v89, v89, v57
v_add_f32 v90, v90, v58
v_add_f32 v91, v91, v59
v_add_f32 v92, v92, v60
v_add_f32 v93, v93, v61
v_add_f32 v94, v94, v62
v_add_f32 v95, v95, v63
v_add_f32 v96, v96, v64
v_add_f32 v97, v97, v65
v_add_f32 v98, v98, v66
v_add_f32 v99, v99, v67
v_add_f32 v100, v100, v68
v_add_f32 v101, v101, v69
v_add_f32 v102, v102, v70
v_add_f32 v103, v103, v71
ds_read_b128 v[56:59], v113 offset:8192
ds_read_b128 v[60:63], v113 offset:9216
ds_read_b128 v[64:67], v113 offset:10240
ds_read_b128 v[68:71], v113 offset:11264
s_waitcnt lgkmcnt(0)
v_add_f32 v88, v88, v56
v_add_f32 v89, v89, v57
v_add_f32 v90, v90, v58
v_add_f32 v91, v91, v59
v_add_f32 v92, v92, v60
v_add_f32 v93, v93, v61
v_add_f32 v94, v94, v62
v_add_f32 v95, v95, v63
v_add_f32 v96, v96, v64
v_add_f32 v97, v97, v65
v_add_f32 v98, v98, v66
v_add_f32 v99, v99, v67
v_add_f32 v100, v100, v68
v_add_f32 v101, v101, v69
v_add_f32 v102, v102, v70
v_add_f32 v103, v103, v71
ds_read_b128 v[56:59], v113 offset:12288
ds_read_b128 v[60:63], v113 offset:13312
ds_read_b128 v[64:67], v113 offset:14336
ds_read_b128 v[68:71], v113 offset:15360
s_waitcnt lgkmcnt(0)
v_add_f32 v88, v88, v56
v_add_f32 v89, v89, v57
v_add_f32 v90, v90, v58
v_add_f32 v91, v91, v59
v_add_f32 v92, v92, v60
v_add_f32 v93, v93, v61
v_add_f32 v94, v94, v62
v_add_f32 v95, v95, v63
v_add_f32 v96, v96, v64
v_add_f32 v97, v97, v65
v_add_f32 v98, v98, v66
v_add_f32 v99, v99, v67
v_add_f32 v100, v100, v68
v_add_f32 v101, v101, v69
v_add_f32 v102, v102, v70
v_add_f32 v103, v103, v71
s_lshl_b32 s3, s24, 7
s_and_b32 s4, s25, 3
s_lshl_b32 s4, s4, 5
s_add_u32 s60, s3, s4
v_and_b32 v104, 31, v0
v_lshrrev_b32 v105, 5, v0
v_lshlrev_b32 v106, 4, v104
v_lshlrev_b32 v107, 3, v104
v_add_u32 v107, 1024, v107
v_lshl_add_u32 v24, v105, 3, v106
v_mul_u32_u24 v108, 504, v105
v_add3_u32 v25, v106, v108, 8
v_add_u32 v26, 512, v24
v_cmp_eq_u32 vcc, 0, v105
v_add_u32 v108, 520, v106
s_nop 0
v_cndmask_b32 v27, v107, v108, vcc
v_add_u32 v108, 196608, v106
v_cndmask_b32 v28, v108, v107, vcc
s_lshr_b32 s4, s60, 5
s_mul_i32 s4, s4, 3072
s_add_u32 s62, s4, 5242880
v_cvt_pk_bf16_f32 v32, v88, v89
v_cvt_pk_bf16_f32 v33, v90, v91
buffer_store_dwordx2 v[32:33], v24, s[20:23], s62 offen
v_cvt_pk_bf16_f32 v34, v92, v93
v_cvt_pk_bf16_f32 v35, v94, v95
buffer_store_dwordx2 v[34:35], v26, s[20:23], s62 offen
s_mov_b32 exec_hi, 0
v_cvt_pk_bf16_f32 v36, v96, v97
v_cvt_pk_bf16_f32 v37, v98, v99
buffer_store_dwordx2 v[36:37], v28, s[20:23], s62 offen
K1_XE0:
s_endpgm
K1_V1:
v_mov_b32 v56, 0
v_mov_b32 v57, 0
v_mov_b32 v58, 0
v_mov_b32 v59, 0
v_mov_b32 v60, 0
v_mov_b32 v61, 0
v_mov_b32 v62, 0
v_mov_b32 v63, 0
v_mov_b32 v64, 0
v_mov_b32 v65, 0
v_mov_b32 v66, 0
v_mov_b32 v67, 0
v_mov_b32 v68, 0
v_mov_b32 v69, 0
v_mov_b32 v70, 0
v_mov_b32 v71, 0
v_mov_b32 v72, 0
v_mov_b32 v73, 0
v_mov_b32 v74, 0
v_mov_b32 v75, 0
v_mov_b32 v76, 0
v_mov_b32 v77, 0
v_mov_b32 v78, 0
v_mov_b32 v79, 0
v_mov_b32 v80, 0
v_mov_b32 v81, 0
v_mov_b32 v82, 0
v_mov_b32 v83, 0
v_mov_b32 v84, 0
v_mov_b32 v85, 0
v_mov_b32 v86, 0
v_mov_b32 v87, 0
v_mov_b32 v88, 0
v_mov_b32 v89, 0
v_mov_b32 v90, 0
v_mov_b32 v91, 0
v_mov_b32 v92, 0
v_mov_b32 v93, 0
v_mov_b32 v94, 0
v_mov_b32 v95, 0
v_mov_b32 v96, 0
v_mov_b32 v97, 0
v_mov_b32 v98, 0
v_mov_b32 v99, 0
v_mov_b32 v100, 0
v_mov_b32 v101, 0
v_mov_b32 v102, 0
v_mov_b32 v103, 0
s_mov_b32 s28, 0
v_add_u32 v16, s28, v10
v_add_u32 v17, s28, v11
v_add_u32 v18, s28, v12
v_add_u32 v19, s28, v13
v_add_u32 v20, s28, v14
v_add_u32 v21, s28, v15
v_add_u32 v23, s28, v22
s_barrier
ds_read_b128 v[24:27], v16
ds_read_b64_tr_b16 v[32:33], v20 offset:192
ds_read_b64_tr_b16 v[34:35], v20 offset:1472
ds_read_b64_tr_b16 v[36:37], v20 offset:256
ds_read_b64_tr_b16 v[38:39], v20 offset:1536
s_mov_b32 s61, 0
.p2align 3
K1_L1:
s_waitcnt lgkmcnt(0)
v_mfma_f32_32x32x16_bf16 v[56:71], v[32:35], v[24:27], v[56:71]
ds_read_b128 v[28:31], v17
ds_read_b64_tr_b16 v[44:45], v20 offset:5312
ds_read_b64_tr_b16 v[46:47], v20 offset:6592
ds_read_b64_tr_b16 v[48:49], v20 offset:5376
ds_read_b64_tr_b16 v[50:51], v20 offset:6656
ds_read_b128 v[52:55], v23
ds_read_b64_tr_b16 v[40:41], v21 offset:0
ds_read_b64_tr_b16 v[42:43], v21 offset:160
v_mfma_f32_32x32x16_bf16 v[72:87], v[36:39], v[24:27], v[72:87]
s_waitcnt lgkmcnt(0)
v_mfma_f32_32x32x16_bf16 v[56:71], v[44:47], v[28:31], v[56:71]
ds_read_b128 v[24:27], v18
ds_read_b64_tr_b16 v[32:33], v20 offset:10432
ds_read_b64_tr_b16 v[34:35], v20 offset:11712
ds_read_b64_tr_b16 v[36:37], v20 offset:10496
ds_read_b64_tr_b16 v[38:39], v20 offset:11776
v_mfma_f32_32x32x16_bf16 v[72:87], v[48:51], v[28:31], v[72:87]
v_mfma_f32_32x32x16_bf16 v[88:103], v[52:55], v[40:43], v[88:103]
s_waitcnt lgkmcnt(0)
v_mfma_f32_32x32x16_bf16 v[56:71], v[32:35], v[24:27], v[56:71]
ds_read_b128 v[28:31], v19
ds_read_b64_tr_b16 v[44:45], v20 offset:15552
ds_read_b64_tr_b16 v[46:47], v20 offset:16832
ds_read_b64_tr_b16 v[48:49], v20 offset:15616
ds_read_b64_tr_b16 v[50:51], v20 offset:16896
s_add_u32 s28, s28, 39936
s_cmp_eq_u32 s28, 159744
s_cselect_b32 s28, 0, s28
v_add_u32 v16, s28, v10
v_add_u32 v17, s28, v11
v_add_u32 v18, s28, v12
v_add_u32 v19, s28, v13
v_add_u32 v20, s28, v14
v_add_u32 v21, s28, v15
v_add_u32 v23, s28, v22
v_mfma_f32_32x32x16_bf16 v[72:87], v[36:39], v[24:27], v[72:87]
s_waitcnt lgkmcnt(0)
s_barrier
ds_read_b128 v[24:27], v16
ds_read_b64_tr_b16 v[32:33], v20 offset:192
ds_read_b64_tr_b16 v[34:35], v20 offset:1472
ds_read_b64_tr_b16 v[36:37], v20 offset:256
ds_read_b64_tr_b16 v[38:39], v20 offset:1536
v_mfma_f32_32x32x16_bf16 v[56:71], v[44:47], v[28:31], v[56:71]
v_mfma_f32_32x32x16_bf16 v[72:87], v[48:51], v[28:31], v[72:87]
s_add_u32 s61, s61, 1
s_cmp_lt_u32 s61, 10
s_cbranch_scc1 K1_L1
s_waitcnt lgkmcnt(0)
s_nop 7
s_nop 7
s_waitcnt vmcnt(0)
s_barrier
s_lshl_b32 s3, s26, 12
s_add_u32 s3, s3, 40960
v_lshlrev_b32 v104, 4, v0
v_add_u32 v113, s3, v104
ds_write_b128 v113, v[88:91] offset:0
ds_write_b128 v113, v[92:95] offset:1024
ds_write_b128 v113, v[96:99] offset:2048
ds_write_b128 v113, v[100:103] offset:3072
v_and_b32 v104, 31, v0
v_lshrrev_b32 v105, 5, v0
s_lshl_b32 s3, s26, 5
v_add_u32 v106, s3, v104
v_mul_u32_u24 v106, 40, v106
v_lshl_add_u32 v24, v105, 3, v106
v_lshl_add_u32 v25, v105, 3, v106
v_add_u32 v25, 8, v25
v_lshl_add_u32 v26, v105, 3, v106
v_add_u32 v26, 16, v26
v_lshl_add_u32 v27, v105, 3, v106
v_add_u32 v27, 24, v27
v_mul_u32_u24 v107, 5088, v105
v_add3_u32 v28, v106, v107, 32
s_mov_b32 s63, 0x3ea52b5c
v_mul_f32 v56, s63, v56
v_mul_f32 v57, s63, v57
v_mul_f32 v58, s63, v58
v_mul_f32 v59, s63, v59
v_cvt_pk_bf16_f32 v32, v56, v57
v_cvt_pk_bf16_f32 v33, v58, v59
ds_write_b64 v28, v[32:33] offset:20480
v_mul_f32 v60, s63, v60
v_mul_f32 v61, s63, v61
v_mul_f32 v62, s63, v62
v_mul_f32 v63, s63, v63
v_cvt_pk_bf16_f32 v34, v60, v61
v_cvt_pk_bf16_f32 v35, v62, v63
ds_write_b64 v25, v[34:35] offset:25600
v_mul_f32 v64, s63, v64
v_mul_f32 v65, s63, v65
v_mul_f32 v66, s63, v66
v_mul_f32 v67, s63, v67
v_cvt_pk_bf16_f32 v36, v64, v65
v_cvt_pk_bf16_f32 v37, v66, v67
ds_write_b64 v27, v[36:37] offset:25600
v_mul_f32 v68, s63, v68
v_mul_f32 v69, s63, v69
v_mul_f32 v70, s63, v70
v_mul_f32 v71, s63, v71
v_cvt_pk_bf16_f32 v38, v68, v69
v_cvt_pk_bf16_f32 v39, v70, v71
ds_write_b64 v24, v[38:39] offset:30720
v_mul_f32 v72, s63, v72
v_mul_f32 v73, s63, v73
v_mul_f32 v74, s63, v74
v_mul_f32 v75, s63, v75
v_cvt_pk_bf16_f32 v40, v72, v73
v_cvt_pk_bf16_f32 v41, v74, v75
ds_write_b64 v26, v[40:41] offset:30720
v_mul_f32 v76, s63, v76
v_mul_f32 v77, s63, v77
v_mul_f32 v78, s63, v78
v_mul_f32 v79, s63, v79
v_cvt_pk_bf16_f32 v42, v76, v77
v_cvt_pk_bf16_f32 v43, v78, v79
ds_write_b64 v28, v[42:43] offset:30720
v_mul_f32 v80, s63, v80
v_mul_f32 v81, s63, v81
v_mul_f32 v82, s63, v82
v_mul_f32 v83, s63, v83
v_cvt_pk_bf16_f32 v44, v80, v81
v_cvt_pk_bf16_f32 v45, v82, v83
ds_write_b64 v25, v[44:45] offset:35840
v_mul_f32 v84, s63, v84
v_mul_f32 v85, s63, v85
v_mul_f32 v86, s63, v86
v_mul_f32 v87, s63, v87
v_cvt_pk_bf16_f32 v46, v84, v85
v_cvt_pk_bf16_f32 v47, v86, v87
ds_write_b64 v27, v[46:47] offset:35840
s_waitcnt lgkmcnt(0)
s_barrier
s_mul_i32 s3, s65, 5120
v_lshlrev_b32 v104, 4, v0
v_add_u32 v105, s3, v104
ds_read_b128 v[32:35], v105 offset:0
ds_read_b128 v[36:39], v105 offset:1024
ds_read_b128 v[40:43], v105 offset:2048
ds_read_b128 v[44:47], v105 offset:3072
ds_read_b128 v[48:51], v105 offset:4096
s_and_b32 s3, s25, 3
s_lshl_b32 s3, s3, 3
s_add_u32 s3, s3, s65
s_mul_i32 s3, s3, 81920
s_cmp_lt_u32 s25, 4
s_cselect_b32 s4, 0, 2621440
s_add_u32 s62, s3, s4
s_mul_i32 s4, s24, 5120
s_add_u32 s62, s62, s4
s_waitcnt lgkmcnt(4)
buffer_store_dwordx4 v[32:35], v104, s[20:23], s62 offen offset:0 sc0 sc1
s_waitcnt lgkmcnt(3)
buffer_store_dwordx4 v[36:39], v104, s[20:23], s62 offen offset:1024 sc0 sc1
s_waitcnt lgkmcnt(2)
buffer_store_dwordx4 v[40:43], v104, s[20:23], s62 offen offset:2048 sc0 sc1
s_waitcnt lgkmcnt(1)
buffer_store_dwordx4 v[44:47], v104, s[20:23], s62 offen offset:3072 sc0 sc1
s_add_u32 s62, s62, 4096
s_waitcnt lgkmcnt(0)
buffer_store_dwordx4 v[48:51], v104, s[20:23], s62 offen sc0 sc1
s_cmp_eq_u32 s26, 0
s_cbranch_scc0 K1_XE1
ds_read_b128 v[56:59], v113 offset:4096
ds_read_b128 v[60:63], v113 offset:5120
ds_read_b128 v[64:67], v113 offset:6144
ds_read_b128 v[68:71], v113 offset:7168
s_waitcnt lgkmcnt(0)
v_add_f32 v88, v88, v56
v_add_f32 v89, v89, v57
v_add_f32 v90, v90, v58
v_add_f32 v91, v91, v59
v_add_f32 v92, v92, v60
v_add_f32 v93, v93, v61
v_add_f32 v94, v94, v62
v_add_f32 v95, v95, v63
v_add_f32 v96, v96, v64
v_add_f32 v97, v97, v65
v_add_f32 v98, v98, v66
v_add_f32 v99, v99, v67
v_add_f32 v100, v100, v68
v_add_f32 v101, v101, v69
v_add_f32 v102, v102, v70
v_add_f32 v103, v103, v71
ds_read_b128 v[56:59], v113 offset:8192
ds_read_b128 v[60:63], v113 offset:9216
ds_read_b128 v[64:67], v113 offset:10240
ds_read_b128 v[68:71], v113 offset:11264
s_waitcnt lgkmcnt(0)
v_add_f32 v88, v88, v56
v_add_f32 v89, v89, v57
v_add_f32 v90, v90, v58
v_add_f32 v91, v91, v59
v_add_f32 v92, v92, v60
v_add_f32 v93, v93, v61
v_add_f32 v94, v94, v62
v_add_f32 v95, v95, v63
v_add_f32 v96, v96, v64
v_add_f32 v97, v97, v65
v_add_f32 v98, v98, v66
v_add_f32 v99, v99, v67
v_add_f32 v100, v100, v68
v_add_f32 v101, v101, v69
v_add_f32 v102, v102, v70
v_add_f32 v103, v103, v71
ds_read_b128 v[56:59], v113 offset:12288
ds_read_b128 v[60:63], v113 offset:13312
ds_read_b128 v[64:67], v113 offset:14336
ds_read_b128 v[68:71], v113 offset:15360
s_waitcnt lgkmcnt(0)
v_add_f32 v88, v88, v56
v_add_f32 v89, v89, v57
v_add_f32 v90, v90, v58
v_add_f32 v91, v91, v59
v_add_f32 v92, v92, v60
v_add_f32 v93, v93, v61
v_add_f32 v94, v94, v62
v_add_f32 v95, v95, v63
v_add_f32 v96, v96, v64
v_add_f32 v97, v97, v65
v_add_f32 v98, v98, v66
v_add_f32 v99, v99, v67
v_add_f32 v100, v100, v68
v_add_f32 v101, v101, v69
v_add_f32 v102, v102, v70
v_add_f32 v103, v103, v71
s_lshl_b32 s3, s24, 7
s_and_b32 s4, s25, 3
s_lshl_b32 s4, s4, 5
s_add_u32 s60, s3, s4
v_and_b32 v104, 31, v0
v_lshrrev_b32 v105, 5, v0
v_mul_u32_u24 v105, 384, v105
v_add_u32 v105, 1536, v105
s_lshr_b32 s4, s60, 5
s_mul_i32 s4, s4, 3072
s_add_u32 s62, s4, 5242880
v_add_u32 v106, 0, v104
v_mul_u32_u24 v107, 52429, v106
v_lshrrev_b32 v107, 20, v107
v_mul_u32_u24 v108, 20, v107
v_sub_u32 v108, v106, v108
v_mul_u32_u24 v107, 196608, v107
v_lshl_add_u32 v108, v108, 4, v107
v_add_u32 v24, v108, v105
v_cmp_gt_u32 vcc, 20, v104
s_and_b64 exec, exec, vcc
v_cvt_pk_bf16_f32 v32, v88, v89
v_cvt_pk_bf16_f32 v33, v90, v91
v_cvt_pk_bf16_f32 v34, v92, v93
v_cvt_pk_bf16_f32 v35, v94, v95
buffer_store_dwordx4 v[32:35], v24, s[20:23], s62 offen offset:0
v_cvt_pk_bf16_f32 v36, v96, v97
v_cvt_pk_bf16_f32 v37, v98, v99
v_cvt_pk_bf16_f32 v38, v100, v101
v_cvt_pk_bf16_f32 v39, v102, v103
buffer_store_dwordx4 v[36:39], v24, s[20:23], s62 offen offset:768
s_mov_b64 exec, -1
v_lshrrev_b32 v104, 2, v0
v_and_b32 v105, 3, v0
v_mul_u32_u24 v104, 196608, v104
v_mul_u32_u24 v105, 384, v105
v_add3_u32 v104, v104, v105, 0
v_add_u32 v104, 1856, v104
v_mov_b32 v108, 0x3f803f80
v_mov_b32 v109, 0x3f803f80
v_mov_b32 v110, 0x3f803f80
v_mov_b32 v111, 0x3f803f80
s_mov_b32 exec_hi, 0
s_mov_b32 exec_lo, 0xf
buffer_store_dwordx4 v[108:111], v104, s[20:23], s62 offen
K1_XE1:
s_endpgm
K1_V2:
v_mov_b32 v56, 0
v_mov_b32 v57, 0
v_mov_b32 v58, 0
v_mov_b32 v59, 0
v_mov_b32 v60, 0
v_mov_b32 v61, 0
v_mov_b32 v62, 0
v_mov_b32 v63, 0
v_mov_b32 v64, 0
v_mov_b32 v65, 0
v_mov_b32 v66, 0
v_mov_b32 v67, 0
v_mov_b32 v68, 0
v_mov_b32 v69, 0
v_mov_b32 v70, 0
v_mov_b32 v71, 0
v_mov_b32 v72, 0
v_mov_b32 v73, 0
v_mov_b32 v74, 0
v_mov_b32 v75, 0
v_mov_b32 v76, 0
v_mov_b32 v77, 0
v_mov_b32 v78, 0
v_mov_b32 v79, 0
v_mov_b32 v80, 0
v_mov_b32 v81, 0
v_mov_b32 v82, 0
v_mov_b32 v83, 0
v_mov_b32 v84, 0
v_mov_b32 v85, 0
v_mov_b32 v86, 0
v_mov_b32 v87, 0
v_mov_b32 v88, 0
v_mov_b32 v89, 0
v_mov_b32 v90, 0
v_mov_b32 v91, 0
v_mov_b32 v92, 0
v_mov_b32 v93, 0
v_mov_b32 v94, 0
v_mov_b32 v95, 0
v_mov_b32 v96, 0
v_mov_b32 v97, 0
v_mov_b32 v98, 0
v_mov_b32 v99, 0
v_mov_b32 v100, 0
v_mov_b32 v101, 0
v_mov_b32 v102, 0
v_mov_b32 v103, 0
s_mov_b32 s28, 0
v_add_u32 v16, s28, v10
v_add_u32 v17, s28, v11
v_add_u32 v18, s28, v12
v_add_u32 v19, s28, v13
v_add_u32 v20, s28, v14
v_add_u32 v21, s28, v15
v_add_u32 v23, s28, v22
s_barrier
ds_read_b128 v[24:27], v16
ds_read_b64_tr_b16 v[32:33], v20 offset:192
ds_read_b64_tr_b16 v[34:35], v20 offset:1472
ds_read_b64_tr_b16 v[36:37], v20 offset:256
ds_read_b64_tr_b16 v[38:39], v20 offset:1536
s_mov_b32 s61, 0
.p2align 3
K1_L2:
s_waitcnt lgkmcnt(0)
v_mfma_f32_32x32x16_bf16 v[56:71], v[32:35], v[24:27], v[56:71]
ds_read_b128 v[28:31], v17
ds_read_b64_tr_b16 v[44:45], v20 offset:5312
ds_read_b64_tr_b16 v[46:47], v20 offset:6592
ds_read_b64_tr_b16 v[48:49], v20 offset:5376
ds_read_b64_tr_b16 v[50:51], v20 offset:6656
ds_read_b128 v[52:55], v23
ds_read_b128 v[40:43], v21
v_mfma_f32_32x32x16_bf16 v[72:87], v[36:39], v[24:27], v[72:87]
s_waitcnt lgkmcnt(0)
v_mfma_f32_32x32x16_bf16 v[56:71], v[44:47], v[28:31], v[56:71]
ds_read_b128 v[24:27], v18
ds_read_b64_tr_b16 v[32:33], v20 offset:10432
ds_read_b64_tr_b16 v[34:35], v20 offset:11712
ds_read_b64_tr_b16 v[36:37], v20 offset:10496
ds_read_b64_tr_b16 v[38:39], v20 offset:11776
v_mfma_f32_32x32x16_bf16 v[72:87], v[48:51], v[28:31], v[72:87]
v_mfma_f32_32x32x16_bf16 v[88:103], v[40:43], v[52:55], v[88:103]
s_waitcnt lgkmcnt(0)
v_mfma_f32_32x32x16_bf16 v[56:71], v[32:35], v[24:27], v[56:71]
ds_read_b128 v[28:31], v19
ds_read_b64_tr_b16 v[44:45], v20 offset:15552
ds_read_b64_tr_b16 v[46:47], v20 offset:16832
ds_read_b64_tr_b16 v[48:49], v20 offset:15616
ds_read_b64_tr_b16 v[50:51], v20 offset:16896
s_add_u32 s28, s28, 39936
s_cmp_eq_u32 s28, 159744
s_cselect_b32 s28, 0, s28
v_add_u32 v16, s28, v10
v_add_u32 v17, s28, v11
v_add_u32 v18, s28, v12
v_add_u32 v19, s28, v13
v_add_u32 v20, s28, v14
v_add_u32 v21, s28, v15
v_add_u32 v23, s28, v22
v_mfma_f32_32x32x16_bf16 v[72:87], v[36:39], v[24:27], v[72:87]
s_waitcnt lgkmcnt(0)
s_barrier
ds_read_b128 v[24:27], v16
ds_read_b64_tr_b16 v[32:33], v20 offset:192
ds_read_b64_tr_b16 v[34:35], v20 offset:1472
ds_read_b64_tr_b16 v[36:37], v20 offset:256
ds_read_b64_tr_b16 v[38:39], v20 offset:1536
v_mfma_f32_32x32x16_bf16 v[56:71], v[44:47], v[28:31], v[56:71]
v_mfma_f32_32x32x16_bf16 v[72:87], v[48:51], v[28:31], v[72:87]
s_add_u32 s61, s61, 1
s_cmp_lt_u32 s61, 10
s_cbranch_scc1 K1_L2
s_waitcnt lgkmcnt(0)
s_nop 7
s_nop 7
s_waitcnt vmcnt(0)
s_barrier
s_lshl_b32 s3, s26, 12
s_add_u32 s3, s3, 40960
v_lshlrev_b32 v104, 4, v0
v_add_u32 v113, s3, v104
ds_write_b128 v113, v[88:91] offset:0
ds_write_b128 v113, v[92:95] offset:1024
ds_write_b128 v113, v[96:99] offset:2048
ds_write_b128 v113, v[100:103] offset:3072
v_and_b32 v104, 31, v0
v_lshrrev_b32 v105, 5, v0
s_mul_i32 s3, s26, 1280
v_lshlrev_b32 v106, 4, v104
v_add_u32 v106, s3, v106
v_lshlrev_b32 v107, 3, v104
v_add_u32 v107, 1024, v107
v_add_u32 v107, s3, v107
v_lshl_add_u32 v24, v105, 3, v106
v_mul_u32_u24 v108, 504, v105
v_add3_u32 v25, v106, v108, 8
v_add_u32 v26, 512, v24
v_cmp_eq_u32 vcc, 0, v105
v_add_u32 v108, 520, v106
s_nop 0
v_cndmask_b32 v27, v107, v108, vcc
v_add_u32 v108, 5120, v106
v_cndmask_b32 v28, v108, v107, vcc
v_cvt_pk_bf16_f32 v32, v56, v57
v_cvt_pk_bf16_f32 v33, v58, v59
ds_write_b64 v28, v[32:33] offset:20480
v_cvt_pk_bf16_f32 v34, v60, v61
v_cvt_pk_bf16_f32 v35, v62, v63
ds_write_b64 v25, v[34:35] offset:25600
v_cvt_pk_bf16_f32 v36, v64, v65
v_cvt_pk_bf16_f32 v37, v66, v67
ds_write_b64 v27, v[36:37] offset:25600
v_cvt_pk_bf16_f32 v38, v68, v69
v_cvt_pk_bf16_f32 v39, v70, v71
ds_write_b64 v24, v[38:39] offset:30720
v_cvt_pk_bf16_f32 v40, v72, v73
v_cvt_pk_bf16_f32 v41, v74, v75
ds_write_b64 v26, v[40:41] offset:30720
v_cvt_pk_bf16_f32 v42, v76, v77
v_cvt_pk_bf16_f32 v43, v78, v79
ds_write_b64 v28, v[42:43] offset:30720
v_cvt_pk_bf16_f32 v44, v80, v81
v_cvt_pk_bf16_f32 v45, v82, v83
ds_write_b64 v25, v[44:45] offset:35840
v_cvt_pk_bf16_f32 v46, v84, v85
v_cvt_pk_bf16_f32 v47, v86, v87
ds_write_b64 v27, v[46:47] offset:35840
s_waitcnt lgkmcnt(0)
s_barrier
s_mul_i32 s3, s65, 5120
v_lshlrev_b32 v104, 4, v0
v_add_u32 v105, s3, v104
ds_read_b128 v[32:35], v105 offset:0
ds_read_b128 v[36:39], v105 offset:1024
ds_read_b128 v[40:43], v105 offset:2048
ds_read_b128 v[44:47], v105 offset:3072
ds_read_b128 v[48:51], v105 offset:4096
s_and_b32 s3, s25, 3
s_lshl_b32 s3, s3, 3
s_add_u32 s3, s3, s65
s_mul_i32 s3, s3, 196608
s_mul_i32 s4, s24, 12288
s_add_u32 s62, s3, s4
s_add_u32 s62, s62, 5439488
v_add_u32 v106, 0, v0
v_mul_u32_u24 v107, 52429, v106
v_lshrrev_b32 v107, 22, v107
v_mul_u32_u24 v107, 1792, v107
v_lshl_add_u32 v24, v106, 4, v107
v_add_u32 v106, 64, v0
v_mul_u32_u24 v107, 52429, v106
v_lshrrev_b32 v107, 22, v107
v_mul_u32_u24 v107, 1792, v107
v_lshl_add_u32 v25, v106, 4, v107
v_add_u32 v106, 128, v0
v_mul_u32_u24 v107, 52429, v106
v_lshrrev_b32 v107, 22, v107
v_mul_u32_u24 v107, 1792, v107
v_lshl_add_u32 v26, v106, 4, v107
v_add_u32 v106, 192, v0
v_mul_u32_u24 v107, 52429, v106
v_lshrrev_b32 v107, 22, v107
v_mul_u32_u24 v107, 1792, v107
v_lshl_add_u32 v27, v106, 4, v107
v_add_u32 v106, 256, v0
v_mul_u32_u24 v107, 52429, v106
v_lshrrev_b32 v107, 22, v107
v_mul_u32_u24 v107, 1792, v107
v_lshl_add_u32 v28, v106, 4, v107
s_waitcnt lgkmcnt(4)
buffer_store_dwordx4 v[32:35], v24, s[20:23], s62 offen sc0 sc1
s_waitcnt lgkmcnt(3)
buffer_store_dwordx4 v[36:39], v25, s[20:23], s62 offen sc0 sc1
s_waitcnt lgkmcnt(2)
buffer_store_dwordx4 v[40:43], v26, s[20:23], s62 offen sc0 sc1
s_waitcnt lgkmcnt(1)
buffer_store_dwordx4 v[44:47], v27, s[20:23], s62 offen sc0 sc1
s_waitcnt lgkmcnt(0)
buffer_store_dwordx4 v[48:51], v28, s[20:23], s62 offen sc0 sc1
s_cmp_eq_u32 s26, 0
s_cbranch_scc0 K1_XE2
ds_read_b128 v[56:59], v113 offset:4096
ds_read_b128 v[60:63], v113 offset:5120
ds_read_b128 v[64:67], v113 offset:6144
ds_read_b128 v[68:71], v113 offset:7168
s_waitcnt lgkmcnt(0)
v_add_f32 v88, v88, v56
v_add_f32 v89, v89, v57
v_add_f32 v90, v90, v58
v_add_f32 v91, v91, v59
v_add_f32 v92, v92, v60
v_add_f32 v93, v93, v61
v_add_f32 v94, v94, v62
v_add_f32 v95, v95, v63
v_add_f32 v96, v96, v64
v_add_f32 v97, v97, v65
v_add_f32 v98, v98, v66
v_add_f32 v99, v99, v67
v_add_f32 v100, v100, v68
v_add_f32 v101, v101, v69
v_add_f32 v102, v102, v70
v_add_f32 v103, v103, v71
ds_read_b128 v[56:59], v113 offset:8192
ds_read_b128 v[60:63], v113 offset:9216
ds_read_b128 v[64:67], v113 offset:10240
ds_read_b128 v[68:71], v113 offset:11264
s_waitcnt lgkmcnt(0)
v_add_f32 v88, v88, v56
v_add_f32 v89, v89, v57
v_add_f32 v90, v90, v58
v_add_f32 v91, v91, v59
v_add_f32 v92, v92, v60
v_add_f32 v93, v93, v61
v_add_f32 v94, v94, v62
v_add_f32 v95, v95, v63
v_add_f32 v96, v96, v64
v_add_f32 v97, v97, v65
v_add_f32 v98, v98, v66
v_add_f32 v99, v99, v67
v_add_f32 v100, v100, v68
v_add_f32 v101, v101, v69
v_add_f32 v102, v102, v70
v_add_f32 v103, v103, v71
ds_read_b128 v[56:59], v113 offset:12288
ds_read_b128 v[60:63], v113 offset:13312
ds_read_b128 v[64:67], v113 offset:14336
ds_read_b128 v[68:71], v113 offset:15360
s_waitcnt lgkmcnt(0)
v_add_f32 v88, v88, v56
v_add_f32 v89, v89, v57
v_add_f32 v90, v90, v58
v_add_f32 v91, v91, v59
v_add_f32 v92, v92, v60
v_add_f32 v93, v93, v61
v_add_f32 v94, v94, v62
v_add_f32 v95, v95, v63
v_add_f32 v96, v96, v64
v_add_f32 v97, v97, v65
v_add_f32 v98, v98, v66
v_add_f32 v99, v99, v67
v_add_f32 v100, v100, v68
v_add_f32 v101, v101, v69
v_add_f32 v102, v102, v70
v_add_f32 v103, v103, v71
s_lshl_b32 s3, s24, 7
s_and_b32 s4, s25, 3
s_lshl_b32 s4, s4, 5
s_add_u32 s60, s3, s4
v_mul_f32 v104, 0xbfb8aa3b, v88
v_exp_f32 v104, v104
v_and_b32 v105, 31, v0
v_add_f32 v104, 1.0, v104
v_rcp_f32 v104, v104
v_add_u32 v105, s60, v105
v_lshlrev_b32 v105, 2, v105
s_mov_b32 exec_hi, 0
s_mov_b32 s62, 11730944
buffer_store_dword v104, v105, s[20:23], s62 offen
K1_XE2:
s_endpgm
K1_V4:
v_mov_b32 v56, 0
v_mov_b32 v57, 0
v_mov_b32 v58, 0
v_mov_b32 v59, 0
v_mov_b32 v60, 0
v_mov_b32 v61, 0
v_mov_b32 v62, 0
v_mov_b32 v63, 0
v_mov_b32 v64, 0
v_mov_b32 v65, 0
v_mov_b32 v66, 0
v_mov_b32 v67, 0
v_mov_b32 v68, 0
v_mov_b32 v69, 0
v_mov_b32 v70, 0
v_mov_b32 v71, 0
v_mov_b32 v72, 0
v_mov_b32 v73, 0
v_mov_b32 v74, 0
v_mov_b32 v75, 0
v_mov_b32 v76, 0
v_mov_b32 v77, 0
v_mov_b32 v78, 0
v_mov_b32 v79, 0
v_mov_b32 v80, 0
v_mov_b32 v81, 0
v_mov_b32 v82, 0
v_mov_b32 v83, 0
v_mov_b32 v84, 0
v_mov_b32 v85, 0
v_mov_b32 v86, 0
v_mov_b32 v87, 0
s_mov_b32 s28, 0
v_add_u32 v16, s28, v10
v_add_u32 v17, s28, v11
v_add_u32 v18, s28, v12
v_add_u32 v19, s28, v13
v_add_u32 v20, s28, v14
s_barrier
ds_read_b128 v[24:27], v16
ds_read_b64_tr_b16 v[32:33], v20 offset:192
ds_read_b64_tr_b16 v[34:35], v20 offset:1472
ds_read_b64_tr_b16 v[36:37], v20 offset:256
ds_read_b64_tr_b16 v[38:39], v20 offset:1536
s_mov_b32 s61, 0
.p2align 3
K1_L4:
s_waitcnt lgkmcnt(0)
v_mfma_f32_32x32x16_bf16 v[56:71], v[24:27], v[32:35], v[56:71]
ds_read_b128 v[28:31], v17
ds_read_b64_tr_b16 v[44:45], v20 offset:5312
ds_read_b64_tr_b16 v[46:47], v20 offset:6592
ds_read_b64_tr_b16 v[48:49], v20 offset:5376
ds_read_b64_tr_b16 v[50:51], v20 offset:6656
v_mfma_f32_32x32x16_bf16 v[72:87], v[24:27], v[36:39], v[72:87]
s_waitcnt lgkmcnt(0)
v_mfma_f32_32x32x16_bf16 v[56:71], v[28:31], v[44:47], v[56:71]
ds_read_b128 v[24:27], v18
ds_read_b64_tr_b16 v[32:33], v20 offset:10432
ds_read_b64_tr_b16 v[34:35], v20 offset:11712
ds_read_b64_tr_b16 v[36:37], v20 offset:10496
ds_read_b64_tr_b16 v[38:39], v20 offset:11776
v_mfma_f32_32x32x16_bf16 v[72:87], v[28:31], v[48:51], v[72:87]
s_waitcnt lgkmcnt(0)
v_mfma_f32_32x32x16_bf16 v[56:71], v[24:27], v[32:35], v[56:71]
ds_read_b128 v[28:31], v19
ds_read_b64_tr_b16 v[44:45], v20 offset:15552
ds_read_b64_tr_b16 v[46:47], v20 offset:16832
ds_read_b64_tr_b16 v[48:49], v20 offset:15616
ds_read_b64_tr_b16 v[50:51], v20 offset:16896
s_add_u32 s28, s28, 39936
s_cmp_eq_u32 s28, 159744
s_cselect_b32 s28, 0, s28
v_add_u32 v16, s28, v10
v_add_u32 v17, s28, v11
v_add_u32 v18, s28, v12
v_add_u32 v19, s28, v13
v_add_u32 v20, s28, v14
v_mfma_f32_32x32x16_bf16 v[72:87], v[24:27], v[36:39], v[72:87]
s_waitcnt lgkmcnt(0)
s_barrier
ds_read_b128 v[24:27], v16
ds_read_b64_tr_b16 v[32:33], v20 offset:192
ds_read_b64_tr_b16 v[34:35], v20 offset:1472
ds_read_b64_tr_b16 v[36:37], v20 offset:256
ds_read_b64_tr_b16 v[38:39], v20 offset:1536
v_mfma_f32_32x32x16_bf16 v[56:71], v[28:31], v[44:47], v[56:71]
v_mfma_f32_32x32x16_bf16 v[72:87], v[28:31], v[48:51], v[72:87]
s_add_u32 s61, s61, 1
s_cmp_lt_u32 s61, 10
s_cbranch_scc1 K1_L4
s_waitcnt lgkmcnt(0)
s_nop 7
s_nop 7
s_waitcnt vmcnt(0)
s_barrier
v_and_b32 v104, 31, v0
v_lshrrev_b32 v105, 5, v0
v_mul_u32_u24 v105, 384, v105
s_mul_i32 s3, s26, 1536
v_add_u32 v105, s3, v105
v_add_u32 v106, 96, v104
v_mul_u32_u24 v107, 52429, v106
v_lshrrev_b32 v107, 20, v107
v_mul_u32_u24 v108, 20, v107
v_sub_u32 v108, v106, v108
v_mul_u32_u24 v107, 6144, v107
v_lshl_add_u32 v108, v108, 4, v107
v_add_u32 v24, v108, v105
v_add_u32 v106, 128, v104
v_mul_u32_u24 v107, 52429, v106
v_lshrrev_b32 v107, 20, v107
v_mul_u32_u24 v108, 20, v107
v_sub_u32 v108, v106, v108
v_mul_u32_u24 v107, 6144, v107
v_lshl_add_u32 v108, v108, 4, v107
v_add_u32 v25, v108, v105
v_cvt_pk_bf16_f32 v32, v56, v57
v_cvt_pk_bf16_f32 v33, v58, v59
v_cvt_pk_bf16_f32 v34, v60, v61
v_cvt_pk_bf16_f32 v35, v62, v63
ds_write_b128 v24, v[32:35] offset:0
v_cvt_pk_bf16_f32 v36, v64, v65
v_cvt_pk_bf16_f32 v37, v66, v67
v_cvt_pk_bf16_f32 v38, v68, v69
v_cvt_pk_bf16_f32 v39, v70, v71
ds_write_b128 v24, v[36:39] offset:768
v_cvt_pk_bf16_f32 v40, v72, v73
v_cvt_pk_bf16_f32 v41, v74, v75
v_cvt_pk_bf16_f32 v42, v76, v77
v_cvt_pk_bf16_f32 v43, v78, v79
ds_write_b128 v25, v[40:43] offset:0
v_cvt_pk_bf16_f32 v44, v80, v81
v_cvt_pk_bf16_f32 v45, v82, v83
v_cvt_pk_bf16_f32 v46, v84, v85
v_cvt_pk_bf16_f32 v47, v86, v87
ds_write_b128 v25, v[44:47] offset:768
v_and_b32 v104, 3, v0
v_cmp_eq_u32 vcc, 0, v104
v_mov_b32 v110, 0x3f803f80
v_bfe_u32 v105, v0, 2, 2
v_cndmask_b32 v110, 0, v110, vcc
v_mul_u32_u24 v105, 384, v105
v_lshl_add_u32 v105, v104, 4, v105
v_lshrrev_b32 v106, 4, v0
v_mul_u32_u24 v106, 6144, v106
s_mul_i32 s3, s26, 1536
s_add_u32 s3, s3, 320
v_add3_u32 v105, v105, v106, s3
v_mov_b32 v111, v110
v_mov_b32 v112, v110
v_mov_b32 v113, v110
ds_write_b128 v105, v[110:113]
ds_write_b128 v105, v[110:113] offset:24576
s_waitcnt lgkmcnt(0)
s_barrier
s_mul_i32 s3, s65, 6144
v_lshlrev_b32 v104, 4, v0
v_add_u32 v105, s3, v104
ds_read_b128 v[32:35], v105 offset:0
ds_read_b128 v[36:39], v105 offset:1024
ds_read_b128 v[40:43], v105 offset:2048
ds_read_b128 v[44:47], v105 offset:3072
ds_read_b128 v[48:51], v105 offset:4096
ds_read_b128 v[52:55], v105 offset:5120
s_and_b32 s3, s25, 3
s_lshl_b32 s3, s3, 3
s_add_u32 s3, s3, s65
s_mul_i32 s3, s3, 196608
s_mul_i32 s4, s24, 12288
s_add_u32 s62, s3, s4
s_add_u32 s62, s62, 5441024
v_add_u32 v106, 0, v0
v_mul_u32_u24 v107, 43691, v106
v_lshrrev_b32 v107, 22, v107
v_mul_u32_u24 v107, 1536, v107
v_lshl_add_u32 v24, v106, 4, v107
v_add_u32 v106, 64, v0
v_mul_u32_u24 v107, 43691, v106
v_lshrrev_b32 v107, 22, v107
v_mul_u32_u24 v107, 1536, v107
v_lshl_add_u32 v25, v106, 4, v107
v_add_u32 v106, 128, v0
v_mul_u32_u24 v107, 43691, v106
v_lshrrev_b32 v107, 22, v107
v_mul_u32_u24 v107, 1536, v107
v_lshl_add_u32 v26, v106, 4, v107
v_add_u32 v106, 192, v0
v_mul_u32_u24 v107, 43691, v106
v_lshrrev_b32 v107, 22, v107
v_mul_u32_u24 v107, 1536, v107
v_lshl_add_u32 v27, v106, 4, v107
v_add_u32 v106, 256, v0
v_mul_u32_u24 v107, 43691, v106
v_lshrrev_b32 v107, 22, v107
v_mul_u32_u24 v107, 1536, v107
v_lshl_add_u32 v28, v106, 4, v107
v_add_u32 v106, 320, v0
v_mul_u32_u24 v107, 43691, v106
v_lshrrev_b32 v107, 22, v107
v_mul_u32_u24 v107, 1536, v107
v_lshl_add_u32 v29, v106, 4, v107
s_waitcnt lgkmcnt(5)
buffer_store_dwordx4 v[32:35], v24, s[20:23], s62 offen sc0 sc1
s_waitcnt lgkmcnt(4)
buffer_store_dwordx4 v[36:39], v25, s[20:23], s62 offen sc0 sc1
s_waitcnt lgkmcnt(3)
buffer_store_dwordx4 v[40:43], v26, s[20:23], s62 offen sc0 sc1
s_waitcnt lgkmcnt(2)
buffer_store_dwordx4 v[44:47], v27, s[20:23], s62 offen sc0 sc1
s_waitcnt lgkmcnt(1)
buffer_store_dwordx4 v[48:51], v28, s[20:23], s62 offen sc0 sc1
s_waitcnt lgkmcnt(0)
buffer_store_dwordx4 v[52:55], v29, s[20:23], s62 offen sc0 sc1
s_endpgm
K1_END:
s_endpgm
.globl attn_kernel
.p2align 8
.type attn_kernel,@function
attn_kernel:
s_cmp_ge_u32 s2, 256
s_cbranch_scc1 K2_END
s_load_dwordx2 s[4:5], s[0:1], 88
v_lshrrev_b32 v1, 6, v0
v_and_b32 v0, 63, v0
s_nop 0
v_readfirstlane_b32 s14, v1
s_and_b32 s12, s2, 7
s_lshl_b32 s12, s12, 1
s_bfe_u32 s3, s2, 0x10003
s_add_u32 s12, s12, s3
s_lshl_b32 s12, s12, 1
s_bfe_u32 s3, s14, 0x10002
s_add_u32 s12, s12, s3
s_lshr_b32 s13, s2, 4
s_waitcnt lgkmcnt(0)
s_mov_b32 s8, s4
s_and_b32 s9, s5, 0xffff
s_mov_b32 s10, 0x10000000
s_mov_b32 s11, 0x20000
s_cmp_ge_u32 s14, 8
s_cbranch_scc1 K2_PROD
s_and_b32 s19, s14, 3
s_lshl_b32 s15, s13, 2
s_add_u32 s15, s15, s19
v_lshrrev_b32 v1, 5, v0
v_and_b32 v14, 31, v0
s_lshl_b32 s3, s15, 5
v_add_u32 v15, s3, v14
v_mul_u32_u24 v139, 40, v15
v_lshl_add_u32 v140, v1, 4, v139
s_mul_i32 s4, s12, 81920
s_add_u32 s34, s4, 2621440
v_lshlrev_b32 v141, 2, v15
buffer_load_dwordx4 v[20:23], v140, s[8:11], s4 offen
buffer_load_dwordx2 v[24:25], v139, s[8:11], s4 offen offset:32
v_lshlrev_b32 v2, 4, v0
s_mul_i32 s18, s14, 3072
s_add_u32 s20, s18, 5242880
s_mov_b32 m0, s18
s_add_u32 s3, s20, 1024
buffer_load_dwordx4 v2, s[8:11], s20 offen lds
s_add_u32 m0, s18, 1024
s_nop 0
buffer_load_dwordx4 v2, s[8:11], s3 offen lds
s_add_u32 m0, s18, 2048
s_add_u32 s3, s20, 2048
buffer_load_dwordx4 v2, s[8:11], s3 offen lds
s_mul_i32 s17, s12, 196608
s_add_u32 s17, s17, 5439488
v_lshlrev_b32 v3, 4, v14
v_lshl_add_u32 v3, v1, 9, v3
v_lshlrev_b32 v4, 3, v14
v_add_u32 v4, 1024, v4
v_mov_b32 v19, 16
v_cmp_gt_u32 vcc, 28, v14
s_nop 1
v_cndmask_b32 v19, v19, 20, vcc
v_cmp_gt_u32 vcc, 20, v14
s_nop 1
v_cndmask_b32 v19, v19, v14, vcc
v_lshlrev_b32 v5, 4, v19
v_mul_u32_u24 v19, 384, v1
v_add3_u32 v5, v5, v19, 0
v_add_u32 v5, 1536, v5
v_mov_b32 v6, v3
v_add_u32 v9, 24576, v3
v_mov_b32 v7, v4
v_add_u32 v10, 24576, v4
v_mov_b32 v8, v5
v_add_u32 v11, 24576, v5
v_mov_b32 v88, 0
v_mov_b32 v89, 0
v_mov_b32 v90, 0
v_mov_b32 v91, 0
v_mov_b32 v92, 0
v_mov_b32 v93, 0
v_mov_b32 v94, 0
v_mov_b32 v95, 0
v_mov_b32 v96, 0
v_mov_b32 v97, 0
v_mov_b32 v98, 0
v_mov_b32 v99, 0
v_mov_b32 v100, 0
v_mov_b32 v101, 0
v_mov_b32 v102, 0
v_mov_b32 v103, 0
v_mov_b32 v44, 0
v_mov_b32 v52, 0
v_mov_b32 v45, 0
v_mov_b32 v53, 0
v_mov_b32 v46, 0
v_mov_b32 v54, 0
v_mov_b32 v47, 0
v_mov_b32 v55, 0
v_lshrrev_b32 v16, 4, v15
v_mul_u32_u24 v16, 40960, v16
v_and_b32 v17, 15, v0
v_lshl_add_u32 v16, v17, 4, v16
s_mul_i32 s3, s12, 5
s_and_b32 s4, s12, 1
v_mov_b32 v120, s4
v_cmp_gt_u32 vcc, v120, v1
s_nop 1
s_mov_b64 s[80:81], vcc
v_cndmask_b32 v120, 0, 1, vcc
s_add_u32 s4, s3, 0
v_add_u32 v17, s4, v1
v_lshl_add_u32 v17, v120, 1, v17
v_lshrrev_b32 v18, 3, v17
v_lshl_add_u32 v18, v18, 10, v16
v_bfe_u32 v19, v17, 1, 2
v_lshl_add_u32 v18, v19, 8, v18
v_and_b32 v19, 1, v17
v_lshl_add_u32 v136, v19, 3, v18
s_add_u32 s4, s3, 2
v_add_u32 v17, s4, v1
v_lshl_add_u32 v17, v120, 1, v17
v_lshrrev_b32 v18, 3, v17
v_lshl_add_u32 v18, v18, 10, v16
v_bfe_u32 v19, v17, 1, 2
v_lshl_add_u32 v18, v19, 8, v18
v_and_b32 v19, 1, v17
v_lshl_add_u32 v137, v19, 3, v18
s_add_u32 s4, s3, 4
v_lshlrev_b32 v17, 2, v120
v_sub_u32 v17, s4, v17
v_lshrrev_b32 v18, 3, v17
v_lshl_add_u32 v18, v18, 10, v16
v_bfe_u32 v19, v17, 1, 2
v_lshl_add_u32 v18, v19, 8, v18
v_and_b32 v19, 1, v17
v_lshl_add_u32 v138, v19, 3, v18
v_lshlrev_b32 v15, 2, v1
v_sub_u32 v14, v14, v15
v_cmp_gt_i32 s[48:49], 0, v14
v_cmp_gt_i32 s[50:51], 1, v14
v_cmp_gt_i32 s[52:53], 2, v14
v_cmp_gt_i32 s[54:55], 3, v14
v_cmp_gt_i32 s[56:57], 8, v14
v_cmp_gt_i32 s[58:59], 9, v14
v_cmp_gt_i32 s[60:61], 10, v14
v_cmp_gt_i32 s[62:63], 11, v14
v_cmp_gt_i32 s[64:65], 16, v14
v_cmp_gt_i32 s[66:67], 17, v14
v_cmp_gt_i32 s[68:69], 18, v14
v_cmp_gt_i32 s[70:71], 19, v14
v_cmp_gt_i32 s[72:73], 24, v14
v_cmp_gt_i32 s[74:75], 25, v14
v_cmp_gt_i32 s[76:77], 26, v14
v_cmp_gt_i32 s[78:79], 27, v14
s_bfe_u32 s3, s14, 0x10002
s_mul_i32 s27, s3, 36864
s_mul_i32 s4, s19, 3072
s_add_u32 s27, s27, s4
s_add_u32 s27, s27, 73728
s_mov_b32 s33, 0x7b800000
s_mov_b32 s96, 0x07060302
s_mov_b32 s16, 0
s_mov_b32 s29, 49152
s_waitcnt vmcnt(0)
s_barrier
ds_read_b128 v[32:35], v6
ds_read_b64 v[36:37], v7
v_cmp_eq_u32 vcc, 0, v1
s_nop 1
v_cndmask_b32 v24, 0, v24, vcc
v_cndmask_b32 v25, 0, v25, vcc
s_waitcnt lgkmcnt(0)
v_mfma_f32_32x32x16_bf16 v[56:71], v[32:35], v[20:23], 0
s_nop 7
s_nop 7
v_mfma_f32_32x32x8_bf16 v[56:71], v[36:37], v[24:25], v[56:71]
ds_read_b128 v[32:35], v6 offset:3072
ds_read_b64 v[36:37], v7 offset:3072
ds_read_b128 v[40:43], v8
s_nop 7
s_nop 7
v_max3_f32 v14, v56, v57, v58
v_max3_f32 v14, v14, v59, v60
v_max3_f32 v14, v14, v61, v62
v_max3_f32 v14, v14, v63, v64
v_max3_f32 v14, v14, v65, v66
v_max3_f32 v14, v14, v67, v68
v_max3_f32 v14, v14, v69, v70
v_max_f32 v14, v14, v71
v_mov_b32 v15, v14
s_nop 1
v_permlane32_swap_b32 v14, v15
s_nop 1
v_max_f32 v14, v14, v15
v_add_f32 v14, 0x42a00000, v14
v_sub_f32 v13, 0, v14
v_pk_add_f32 v[56:57], v[56:57], v[12:13] op_sel:[0,1] op_sel_hi:[1,1]
v_pk_mov_b32 v[104:105], v[12:13], v[12:13] op_sel:[1,1]
v_pk_add_f32 v[58:59], v[58:59], v[12:13] op_sel:[0,1] op_sel_hi:[1,1]
v_pk_mov_b32 v[106:107], v[12:13], v[12:13] op_sel:[1,1]
v_pk_add_f32 v[60:61], v[60:61], v[12:13] op_sel:[0,1] op_sel_hi:[1,1]
v_pk_mov_b32 v[108:109], v[12:13], v[12:13] op_sel:[1,1]
v_pk_add_f32 v[62:63], v[62:63], v[12:13] op_sel:[0,1] op_sel_hi:[1,1]
v_pk_mov_b32 v[110:111], v[12:13], v[12:13] op_sel:[1,1]
v_pk_add_f32 v[64:65], v[64:65], v[12:13] op_sel:[0,1] op_sel_hi:[1,1]
v_pk_mov_b32 v[112:113], v[12:13], v[12:13] op_sel:[1,1]
v_pk_add_f32 v[66:67], v[66:67], v[12:13] op_sel:[0,1] op_sel_hi:[1,1]
v_pk_mov_b32 v[114:115], v[12:13], v[12:13] op_sel:[1,1]
v_pk_add_f32 v[68:69], v[68:69], v[12:13] op_sel:[0,1] op_sel_hi:[1,1]
v_pk_mov_b32 v[116:117], v[12:13], v[12:13] op_sel:[1,1]
v_pk_add_f32 v[70:71], v[70:71], v[12:13] op_sel:[0,1] op_sel_hi:[1,1]
v_pk_mov_b32 v[118:119], v[12:13], v[12:13] op_sel:[1,1]
s_waitcnt lgkmcnt(0)
.p2align 3
K2_LA:
s_setprio 2
s_waitcnt lgkmcnt(3)
v_mfma_f32_32x32x16_bf16 v[72:87], v[32:35], v[20:23], v[104:119]
ds_read_b128 v[32:35], v6 offset:6144
v_exp_f32 v56, v56
v_exp_f32 v57, v57
v_exp_f32 v58, v58
v_exp_f32 v59, v59
v_cvt_pk_bf16_f32 v48, v56, v57
v_cvt_pk_bf16_f32 v49, v58, v59
s_waitcnt lgkmcnt(3)
v_mfma_f32_32x32x16_bf16 v[88:103], v[44:47], v[52:55], v[88:103]
ds_read_b128 v[44:47], v8 offset:768
v_exp_f32 v60, v60
v_exp_f32 v61, v61
v_exp_f32 v62, v62
v_exp_f32 v63, v63
v_cvt_pk_bf16_f32 v50, v60, v61
v_cvt_pk_bf16_f32 v51, v62, v63
s_waitcnt lgkmcnt(3)
v_mfma_f32_32x32x8_bf16 v[72:87], v[36:37], v[24:25], v[72:87]
ds_read_b64 v[36:37], v7 offset:6144
v_exp_f32 v64, v64
v_exp_f32 v65, v65
v_exp_f32 v66, v66
v_exp_f32 v67, v67
v_cvt_pk_bf16_f32 v52, v64, v65
v_cvt_pk_bf16_f32 v53, v66, v67
s_waitcnt lgkmcnt(3)
v_mfma_f32_32x32x16_bf16 v[88:103], v[40:43], v[48:51], v[88:103]
ds_read_b128 v[40:43], v8 offset:3072
v_exp_f32 v68, v68
v_exp_f32 v69, v69
v_exp_f32 v70, v70
v_exp_f32 v71, v71
v_cvt_pk_bf16_f32 v54, v68, v69
v_cvt_pk_bf16_f32 v55, v70, v71
s_waitcnt lgkmcnt(3)
v_mfma_f32_32x32x16_bf16 v[56:71], v[32:35], v[20:23], v[104:119]
ds_read_b128 v[32:35], v6 offset:9216
v_exp_f32 v72, v72
v_exp_f32 v73, v73
v_exp_f32 v74, v74
v_exp_f32 v75, v75
v_cvt_pk_bf16_f32 v48, v72, v73
v_cvt_pk_bf16_f32 v49, v74, v75
s_waitcnt lgkmcnt(3)
v_mfma_f32_32x32x16_bf16 v[88:103], v[44:47], v[52:55], v[88:103]
ds_read_b128 v[44:47], v8 offset:3840
v_exp_f32 v76, v76
v_exp_f32 v77, v77
v_exp_f32 v78, v78
v_exp_f32 v79, v79
v_cvt_pk_bf16_f32 v50, v76, v77
v_cvt_pk_bf16_f32 v51, v78, v79
s_waitcnt lgkmcnt(3)
v_mfma_f32_32x32x8_bf16 v[56:71], v[36:37], v[24:25], v[56:71]
ds_read_b64 v[36:37], v7 offset:9216
v_exp_f32 v80, v80
v_exp_f32 v81, v81
v_exp_f32 v82, v82
v_exp_f32 v83, v83
v_cvt_pk_bf16_f32 v52, v80, v81
v_cvt_pk_bf16_f32 v53, v82, v83
s_waitcnt lgkmcnt(3)
v_mfma_f32_32x32x16_bf16 v[88:103], v[40:43], v[48:51], v[88:103]
ds_read_b128 v[40:43], v8 offset:6144
v_exp_f32 v84, v84
v_exp_f32 v85, v85
v_exp_f32 v86, v86
v_exp_f32 v87, v87
v_cvt_pk_bf16_f32 v54, v84, v85
v_cvt_pk_bf16_f32 v55, v86, v87
s_setprio 1
s_waitcnt lgkmcnt(3)
v_mfma_f32_32x32x16_bf16 v[72:87], v[32:35], v[20:23], v[104:119]
ds_read_b128 v[32:35], v6 offset:12288
v_exp_f32 v56, v56
v_exp_f32 v57, v57
v_exp_f32 v58, v58
v_exp_f32 v59, v59
v_cvt_pk_bf16_f32 v48, v56, v57
v_cvt_pk_bf16_f32 v49, v58, v59
s_waitcnt lgkmcnt(3)
v_mfma_f32_32x32x16_bf16 v[88:103], v[44:47], v[52:55], v[88:103]
ds_read_b128 v[44:47], v8 offset:6912
v_exp_f32 v60, v60
v_exp_f32 v61, v61
v_exp_f32 v62, v62
v_exp_f32 v63, v63
v_cvt_pk_bf16_f32 v50, v60, v61
v_cvt_pk_bf16_f32 v51, v62, v63
s_waitcnt lgkmcnt(3)
v_mfma_f32_32x32x8_bf16 v[72:87], v[36:37], v[24:25], v[72:87]
ds_read_b64 v[36:37], v7 offset:12288
v_exp_f32 v64, v64
v_exp_f32 v65, v65
v_exp_f32 v66, v66
v_exp_f32 v67, v67
v_cvt_pk_bf16_f32 v52, v64, v65
v_cvt_pk_bf16_f32 v53, v66, v67
s_waitcnt lgkmcnt(3)
v_mfma_f32_32x32x16_bf16 v[88:103], v[40:43], v[48:51], v[88:103]
ds_read_b128 v[40:43], v8 offset:9216
v_exp_f32 v68, v68
v_exp_f32 v69, v69
v_exp_f32 v70, v70
v_exp_f32 v71, v71
v_cvt_pk_bf16_f32 v54, v68, v69
v_cvt_pk_bf16_f32 v55, v70, v71
s_waitcnt lgkmcnt(3)
v_mfma_f32_32x32x16_bf16 v[56:71], v[32:35], v[20:23], v[104:119]
ds_read_b128 v[32:35], v6 offset:15360
v_exp_f32 v72, v72
v_exp_f32 v73, v73
v_exp_f32 v74, v74
v_exp_f32 v75, v75
v_cvt_pk_bf16_f32 v48, v72, v73
v_cvt_pk_bf16_f32 v49, v74, v75
s_waitcnt lgkmcnt(3)
v_mfma_f32_32x32x16_bf16 v[88:103], v[44:47], v[52:55], v[88:103]
ds_read_b128 v[44:47], v8 offset:9984
v_exp_f32 v76, v76
v_exp_f32 v77, v77
v_exp_f32 v78, v78
v_exp_f32 v79, v79
v_cvt_pk_bf16_f32 v50, v76, v77
v_cvt_pk_bf16_f32 v51, v78, v79
s_waitcnt lgkmcnt(3)
v_mfma_f32_32x32x8_bf16 v[56:71], v[36:37], v[24:25], v[56:71]
ds_read_b64 v[36:37], v7 offset:15360
v_exp_f32 v80, v80
v_exp_f32 v81, v81
v_exp_f32 v82, v82
v_exp_f32 v83, v83
v_cvt_pk_bf16_f32 v52, v80, v81
v_cvt_pk_bf16_f32 v53, v82, v83
s_waitcnt lgkmcnt(3)
v_mfma_f32_32x32x16_bf16 v[88:103], v[40:43], v[48:51], v[88:103]
ds_read_b128 v[40:43], v8 offset:12288
v_exp_f32 v84, v84
v_exp_f32 v85, v85
v_exp_f32 v86, v86
v_exp_f32 v87, v87
v_cvt_pk_bf16_f32 v54, v84, v85
v_cvt_pk_bf16_f32 v55, v86, v87
s_setprio 0
s_waitcnt lgkmcnt(3)
v_mfma_f32_32x32x16_bf16 v[72:87], v[32:35], v[20:23], v[104:119]
ds_read_b128 v[32:35], v6 offset:18432
v_exp_f32 v56, v56
v_exp_f32 v57, v57
v_exp_f32 v58, v58
v_exp_f32 v59, v59
v_cvt_pk_bf16_f32 v48, v56, v57
v_cvt_pk_bf16_f32 v49, v58, v59
s_waitcnt lgkmcnt(3)
v_mfma_f32_32x32x16_bf16 v[88:103], v[44:47], v[52:55], v[88:103]
ds_read_b128 v[44:47], v8 offset:13056
v_exp_f32 v60, v60
v_exp_f32 v61, v61
v_exp_f32 v62, v62
v_exp_f32 v63, v63
v_cvt_pk_bf16_f32 v50, v60, v61
v_cvt_pk_bf16_f32 v51, v62, v63
s_waitcnt lgkmcnt(3)
v_mfma_f32_32x32x8_bf16 v[72:87], v[36:37], v[24:25], v[72:87]
ds_read_b64 v[36:37], v7 offset:18432
v_exp_f32 v64, v64
v_exp_f32 v65, v65
v_exp_f32 v66, v66
v_exp_f32 v67, v67
v_cvt_pk_bf16_f32 v52, v64, v65
v_cvt_pk_bf16_f32 v53, v66, v67
s_waitcnt lgkmcnt(3)
v_mfma_f32_32x32x16_bf16 v[88:103], v[40:43], v[48:51], v[88:103]
ds_read_b128 v[40:43], v8 offset:15360
v_exp_f32 v68, v68
v_exp_f32 v69, v69
v_exp_f32 v70, v70
v_exp_f32 v71, v71
v_cvt_pk_bf16_f32 v54, v68, v69
v_cvt_pk_bf16_f32 v55, v70, v71
s_waitcnt lgkmcnt(3)
v_mfma_f32_32x32x16_bf16 v[56:71], v[32:35], v[20:23], v[104:119]
ds_read_b128 v[32:35], v6 offset:21504
v_exp_f32 v72, v72
v_exp_f32 v73, v73
v_exp_f32 v74, v74
v_exp_f32 v75, v75
v_cvt_pk_bf16_f32 v48, v72, v73
v_cvt_pk_bf16_f32 v49, v74, v75
s_waitcnt lgkmcnt(3)
v_mfma_f32_32x32x16_bf16 v[88:103], v[44:47], v[52:55], v[88:103]
ds_read_b128 v[44:47], v8 offset:16128
v_exp_f32 v76, v76
v_exp_f32 v77, v77
v_exp_f32 v78, v78
v_exp_f32 v79, v79
v_cvt_pk_bf16_f32 v50, v76, v77
v_cvt_pk_bf16_f32 v51, v78, v79
s_waitcnt lgkmcnt(3)
v_mfma_f32_32x32x8_bf16 v[56:71], v[36:37], v[24:25], v[56:71]
ds_read_b64 v[36:37], v7 offset:21504
v_exp_f32 v80, v80
v_exp_f32 v81, v81
v_exp_f32 v82, v82
v_exp_f32 v83, v83
v_cvt_pk_bf16_f32 v52, v80, v81
v_cvt_pk_bf16_f32 v53, v82, v83
s_waitcnt lgkmcnt(3)
v_mfma_f32_32x32x16_bf16 v[88:103], v[40:43], v[48:51], v[88:103]
ds_read_b128 v[40:43], v8 offset:18432
v_exp_f32 v84, v84
v_exp_f32 v85, v85
v_exp_f32 v86, v86
v_exp_f32 v87, v87
v_cvt_pk_bf16_f32 v54, v84, v85
v_cvt_pk_bf16_f32 v55, v86, v87
s_barrier
s_setprio 3
s_waitcnt lgkmcnt(3)
v_mfma_f32_32x32x16_bf16 v[72:87], v[32:35], v[20:23], v[104:119]
ds_read_b128 v[32:35], v9 offset:0
v_exp_f32 v56, v56
v_exp_f32 v57, v57
v_exp_f32 v58, v58
v_exp_f32 v59, v59
v_cvt_pk_bf16_f32 v48, v56, v57
v_cvt_pk_bf16_f32 v49, v58, v59
s_waitcnt lgkmcnt(3)
v_mfma_f32_32x32x16_bf16 v[88:103], v[44:47], v[52:55], v[88:103]
ds_read_b128 v[44:47], v8 offset:19200
v_exp_f32 v60, v60
v_exp_f32 v61, v61
v_exp_f32 v62, v62
v_exp_f32 v63, v63
v_cvt_pk_bf16_f32 v50, v60, v61
v_cvt_pk_bf16_f32 v51, v62, v63
s_waitcnt lgkmcnt(3)
v_mfma_f32_32x32x8_bf16 v[72:87], v[36:37], v[24:25], v[72:87]
ds_read_b64 v[36:37], v10 offset:0
v_exp_f32 v64, v64
v_exp_f32 v65, v65
v_exp_f32 v66, v66
v_exp_f32 v67, v67
v_cvt_pk_bf16_f32 v52, v64, v65
v_cvt_pk_bf16_f32 v53, v66, v67
s_waitcnt lgkmcnt(3)
v_mfma_f32_32x32x16_bf16 v[88:103], v[40:43], v[48:51], v[88:103]
ds_read_b128 v[40:43], v8 offset:21504
v_exp_f32 v68, v68
v_exp_f32 v69, v69
v_exp_f32 v70, v70
v_exp_f32 v71, v71
v_cvt_pk_bf16_f32 v54, v68, v69
v_cvt_pk_bf16_f32 v55, v70, v71
s_waitcnt lgkmcnt(3)
v_mfma_f32_32x32x16_bf16 v[56:71], v[32:35], v[20:23], v[104:119]
ds_read_b128 v[32:35], v9 offset:3072
v_exp_f32 v72, v72
v_exp_f32 v73, v73
v_exp_f32 v74, v74
v_exp_f32 v75, v75
v_cvt_pk_bf16_f32 v48, v72, v73
v_cvt_pk_bf16_f32 v49, v74, v75
s_waitcnt lgkmcnt(3)
v_mfma_f32_32x32x16_bf16 v[88:103], v[44:47], v[52:55], v[88:103]
ds_read_b128 v[44:47], v8 offset:22272
v_exp_f32 v76, v76
v_exp_f32 v77, v77
v_exp_f32 v78, v78
v_exp_f32 v79, v79
v_cvt_pk_bf16_f32 v50, v76, v77
v_cvt_pk_bf16_f32 v51, v78, v79
s_waitcnt lgkmcnt(3)
v_mfma_f32_32x32x8_bf16 v[56:71], v[36:37], v[24:25], v[56:71]
ds_read_b64 v[36:37], v10 offset:3072
v_exp_f32 v80, v80
v_exp_f32 v81, v81
v_exp_f32 v82, v82
v_exp_f32 v83, v83
v_cvt_pk_bf16_f32 v52, v80, v81
v_cvt_pk_bf16_f32 v53, v82, v83
s_waitcnt lgkmcnt(3)
v_mfma_f32_32x32x16_bf16 v[88:103], v[40:43], v[48:51], v[88:103]
ds_read_b128 v[40:43], v11 offset:0
v_exp_f32 v84, v84
v_exp_f32 v85, v85
v_exp_f32 v86, v86
v_exp_f32 v87, v87
v_cvt_pk_bf16_f32 v54, v84, v85
v_cvt_pk_bf16_f32 v55, v86, v87
s_cmp_eq_u32 s16, 3
s_cbranch_scc0 K2_NOQB
s_mov_b32 s6, 11730944
buffer_load_dwordx4 v[26:29], v140, s[8:11], s34 offen
buffer_load_dwordx2 v[30:31], v139, s[8:11], s34 offen offset:32
buffer_load_dword v12, v141, s[8:11], s6 offen
K2_NOQB:
v_mov_b32 v6, v9
v_add_u32 v9, s29, v3
v_mov_b32 v7, v10
v_add_u32 v10, s29, v4
v_mov_b32 v8, v11
v_add_u32 v11, s29, v5
s_add_u32 s29, s29, 24576
s_cmp_eq_u32 s29, 73728
s_cselect_b32 s29, 0, s29
s_add_u32 s16, s16, 1
s_cmp_lt_u32 s16, 8
s_cbranch_scc1 K2_LA
s_waitcnt lgkmcnt(0)
v_mfma_f32_32x32x16_bf16 v[88:103], v[44:47], v[52:55], v[88:103]
s_nop 7
s_nop 7
s_waitcnt vmcnt(0)
v_cmp_eq_u32 vcc, 0, v1
s_nop 1
v_cndmask_b32 v30, 0, v30, vcc
v_cndmask_b32 v31, 0, v31, vcc
v_cmp_eq_u32 vcc, 0, v1
s_nop 1
v_cndmask_b32 v14, v96, v100, vcc
v_mov_b32 v16, v14
v_mov_b32 v17, 0
v_pk_fma_f32 v[16:17], v[88:89], 0, v[16:17]
v_pk_fma_f32 v[16:17], v[90:91], 0, v[16:17]
v_pk_fma_f32 v[16:17], v[92:93], 0, v[16:17]
v_pk_fma_f32 v[16:17], v[94:95], 0, v[16:17]
v_pk_fma_f32 v[16:17], v[96:97], 0, v[16:17]
v_pk_fma_f32 v[16:17], v[98:99], 0, v[16:17]
v_add_f32 v15, v16, v17
v_cmp_gt_f32 vcc, s33, v15
s_nop 4
s_cmp_eq_u64 vcc, -1
s_cbranch_scc1 K2_OKA
s_mov_b32 s40, 0
s_mov_b32 s41, 64
s_mov_b32 s42, 5242880
v_mov_b32 v14, 0xf149f2ca
s_mov_b32 s43, s40
K2_SLA_1:
s_mul_i32 s44, s43, 3072
s_add_u32 s44, s44, s42
buffer_load_dwordx4 v[32:35], v3, s[8:11], s44 offen
buffer_load_dwordx2 v[36:37], v4, s[8:11], s44 offen
s_waitcnt vmcnt(0)
v_mfma_f32_32x32x16_bf16 v[56:71], v[32:35], v[20:23], 0
s_nop 7
s_nop 7
v_mfma_f32_32x32x8_bf16 v[56:71], v[36:37], v[24:25], v[56:71]
s_nop 7
s_nop 7
v_max_f32 v14, v14, v56
v_max_f32 v14, v14, v57
v_max_f32 v14, v14, v58
v_max_f32 v14, v14, v59
v_max_f32 v14, v14, v60
v_max_f32 v14, v14, v61
v_max_f32 v14, v14, v62
v_max_f32 v14, v14, v63
v_max_f32 v14, v14, v64
v_max_f32 v14, v14, v65
v_max_f32 v14, v14, v66
v_max_f32 v14, v14, v67
v_max_f32 v14, v14, v68
v_max_f32 v14, v14, v69
v_max_f32 v14, v14, v70
v_max_f32 v14, v14, v71
s_add_u32 s43, s43, 1
s_cmp_lt_u32 s43, s41
s_cbranch_scc1 K2_SLA_1
v_mov_b32 v15, v14
s_nop 1
v_permlane32_swap_b32 v14, v15
s_nop 1
v_max_f32 v14, v14, v15
v_mov_b32 v88, 0
v_mov_b32 v89, 0
v_mov_b32 v90, 0
v_mov_b32 v91, 0
v_mov_b32 v92, 0
v_mov_b32 v93, 0
v_mov_b32 v94, 0
v_mov_b32 v95, 0
v_mov_b32 v96, 0
v_mov_b32 v97, 0
v_mov_b32 v98, 0
v_mov_b32 v99, 0
v_mov_b32 v100, 0
v_mov_b32 v101, 0
v_mov_b32 v102, 0
v_mov_b32 v103, 0
s_mov_b32 s43, s40
K2_SLA_2:
s_mul_i32 s44, s43, 3072
s_add_u32 s44, s44, s42
buffer_load_dwordx4 v[32:35], v3, s[8:11], s44 offen
buffer_load_dwordx2 v[36:37], v4, s[8:11], s44 offen
buffer_load_dwordx4 v[40:43], v5, s[8:11], s44 offen
buffer_load_dwordx4 v[44:47], v5, s[8:11], s44 offen offset:768
s_waitcnt vmcnt(0)
v_mfma_f32_32x32x16_bf16 v[56:71], v[32:35], v[20:23], 0
s_nop 7
s_nop 7
v_mfma_f32_32x32x8_bf16 v[56:71], v[36:37], v[24:25], v[56:71]
s_nop 7
s_nop 7
v_sub_f32 v56, v56, v14
v_exp_f32 v56, v56
v_sub_f32 v57, v57, v14
v_exp_f32 v57, v57
v_sub_f32 v58, v58, v14
v_exp_f32 v58, v58
v_sub_f32 v59, v59, v14
v_exp_f32 v59, v59
v_sub_f32 v60, v60, v14
v_exp_f32 v60, v60
v_sub_f32 v61, v61, v14
v_exp_f32 v61, v61
v_sub_f32 v62, v62, v14
v_exp_f32 v62, v62
v_sub_f32 v63, v63, v14
v_exp_f32 v63, v63
v_sub_f32 v64, v64, v14
v_exp_f32 v64, v64
v_sub_f32 v65, v65, v14
v_exp_f32 v65, v65
v_sub_f32 v66, v66, v14
v_exp_f32 v66, v66
v_sub_f32 v67, v67, v14
v_exp_f32 v67, v67
v_sub_f32 v68, v68, v14
v_exp_f32 v68, v68
v_sub_f32 v69, v69, v14
v_exp_f32 v69, v69
v_sub_f32 v70, v70, v14
v_exp_f32 v70, v70
v_sub_f32 v71, v71, v14
v_exp_f32 v71, v71
s_nop 0
v_cvt_pk_bf16_f32 v48, v56, v57
v_cvt_pk_bf16_f32 v49, v58, v59
v_cvt_pk_bf16_f32 v50, v60, v61
v_cvt_pk_bf16_f32 v51, v62, v63
v_cvt_pk_bf16_f32 v52, v64, v65
v_cvt_pk_bf16_f32 v53, v66, v67
v_cvt_pk_bf16_f32 v54, v68, v69
v_cvt_pk_bf16_f32 v55, v70, v71
s_nop 1
v_mfma_f32_32x32x16_bf16 v[88:103], v[40:43], v[48:51], v[88:103]
s_nop 7
s_nop 7
v_mfma_f32_32x32x16_bf16 v[88:103], v[44:47], v[52:55], v[88:103]
s_nop 7
s_nop 7
s_add_u32 s43, s43, 1
s_cmp_lt_u32 s43, s41
s_cbranch_scc1 K2_SLA_2
v_cmp_eq_u32 vcc, 0, v1
s_nop 1
v_cndmask_b32 v14, v96, v100, vcc
K2_OKA:
v_rcp_f32 v14, v14
v_mov_b32 v15, v12
v_mul_f32 v14, v14, v15
v_pk_mul_f32 v[88:89], v[88:89], v[14:15] op_sel:[0,0] op_sel_hi:[1,0]
v_pk_mul_f32 v[90:91], v[90:91], v[14:15] op_sel:[0,0] op_sel_hi:[1,0]
v_pk_mul_f32 v[92:93], v[92:93], v[14:15] op_sel:[0,0] op_sel_hi:[1,0]
v_pk_mul_f32 v[94:95], v[94:95], v[14:15] op_sel:[0,0] op_sel_hi:[1,0]
v_pk_mul_f32 v[96:97], v[96:97], v[14:15] op_sel:[0,0] op_sel_hi:[1,0]
v_pk_mul_f32 v[98:99], v[98:99], v[14:15] op_sel:[0,0] op_sel_hi:[1,0]
s_mov_b32 s5, 11796480
v_cvt_pk_bf16_f32 v48, v88, v89
v_cvt_pk_bf16_f32 v49, v90, v91
v_cvt_pk_bf16_f32 v50, v92, v93
v_cvt_pk_bf16_f32 v51, v94, v95
v_cvt_pk_bf16_f32 v52, v96, v97
v_cvt_pk_bf16_f32 v53, v98, v99
v_cndmask_b32 v72, v48, v50, s[80:81]
v_cndmask_b32 v73, v49, v51, s[80:81]
buffer_store_dwordx2 v[72:73], v136, s[8:11], s5 offen sc0 sc1
v_cndmask_b32 v74, v50, v52, s[80:81]
v_cndmask_b32 v75, v51, v53, s[80:81]
buffer_store_dwordx2 v[74:75], v137, s[8:11], s5 offen sc0 sc1
v_cndmask_b32 v76, v52, v48, s[80:81]
v_cndmask_b32 v77, v53, v49, s[80:81]
s_mov_b32 exec_hi, 0
buffer_store_dwordx2 v[76:77], v138, s[8:11], s5 offen sc0 sc1
s_mov_b64 exec, -1
v_add_u32 v6, s27, v3
v_add_u32 v7, s27, v4
v_add_u32 v8, s27, v5
ds_read_b128 v[32:35], v6 offset:24576
ds_read_b64 v[36:37], v7 offset:24576
v_mov_b32 v16, 0xf149f2ca
v_cndmask_b32 v104, 0, v16, s[48:49]
v_cndmask_b32 v105, 0, v16, s[50:51]
v_cndmask_b32 v106, 0, v16, s[52:53]
v_cndmask_b32 v107, 0, v16, s[54:55]
v_cndmask_b32 v108, 0, v16, s[56:57]
v_cndmask_b32 v109, 0, v16, s[58:59]
v_cndmask_b32 v110, 0, v16, s[60:61]
v_cndmask_b32 v111, 0, v16, s[62:63]
v_cndmask_b32 v112, 0, v16, s[64:65]
v_cndmask_b32 v113, 0, v16, s[66:67]
v_cndmask_b32 v114, 0, v16, s[68:69]
v_cndmask_b32 v115, 0, v16, s[70:71]
v_cndmask_b32 v116, 0, v16, s[72:73]
v_cndmask_b32 v117, 0, v16, s[74:75]
v_cndmask_b32 v118, 0, v16, s[76:77]
v_cndmask_b32 v119, 0, v16, s[78:79]
s_waitcnt lgkmcnt(0)
s_nop 1
v_mfma_f32_32x32x16_bf16 v[56:71], v[32:35], v[26:29], v[104:119]
s_nop 7
s_nop 7
v_mfma_f32_32x32x8_bf16 v[56:71], v[36:37], v[30:31], v[56:71]
ds_read_b128 v[32:35], v6
ds_read_b64 v[36:37], v7
ds_read_b128 v[40:43], v8 offset:24576
s_nop 7
s_nop 7
v_max3_f32 v14, v56, v57, v58
v_max3_f32 v14, v14, v59, v60
v_max3_f32 v14, v14, v61, v62
v_max3_f32 v14, v14, v63, v64
v_max3_f32 v14, v14, v65, v66
v_max3_f32 v14, v14, v67, v68
v_max3_f32 v14, v14, v69, v70
v_max_f32 v14, v14, v71
v_mov_b32 v15, v14
s_nop 1
v_permlane32_swap_b32 v14, v15
s_nop 1
v_max_f32 v14, v14, v15
v_add_f32 v14, 0x42a00000, v14
v_sub_f32 v13, 0, v14
s_sub_i32 s31, 8, s15
s_max_i32 s31, s31, 0
v_mov_b32 v16, 0xf149f2ca
s_cmp_ge_u32 s31, 1
s_cselect_b64 vcc, -1, 0
v_cndmask_b32 v17, v13, v16, vcc
s_cmp_ge_u32 s31, 2
s_cselect_b64 vcc, -1, 0
v_cndmask_b32 v18, v13, v16, vcc
v_pk_add_f32 v[56:57], v[56:57], v[12:13] op_sel:[0,1] op_sel_hi:[1,1]
v_pk_mov_b32 v[104:105], v[18:19], v[18:19] op_sel:[0,0]
v_cndmask_b32 v120, v16, v17, s[48:49]
v_cndmask_b32 v121, v16, v17, s[50:51]
v_pk_add_f32 v[58:59], v[58:59], v[12:13] op_sel:[0,1] op_sel_hi:[1,1]
v_pk_mov_b32 v[106:107], v[18:19], v[18:19] op_sel:[0,0]
v_cndmask_b32 v122, v16, v17, s[52:53]
v_cndmask_b32 v123, v16, v17, s[54:55]
v_pk_add_f32 v[60:61], v[60:61], v[12:13] op_sel:[0,1] op_sel_hi:[1,1]
v_pk_mov_b32 v[108:109], v[18:19], v[18:19] op_sel:[0,0]
v_cndmask_b32 v124, v16, v17, s[56:57]
v_cndmask_b32 v125, v16, v17, s[58:59]
v_pk_add_f32 v[62:63], v[62:63], v[12:13] op_sel:[0,1] op_sel_hi:[1,1]
v_pk_mov_b32 v[110:111], v[18:19], v[18:19] op_sel:[0,0]
v_cndmask_b32 v126, v16, v17, s[60:61]
v_cndmask_b32 v127, v16, v17, s[62:63]
v_pk_add_f32 v[64:65], v[64:65], v[12:13] op_sel:[0,1] op_sel_hi:[1,1]
v_pk_mov_b32 v[112:113], v[18:19], v[18:19] op_sel:[0,0]
v_cndmask_b32 v128, v16, v17, s[64:65]
v_cndmask_b32 v129, v16, v17, s[66:67]
v_pk_add_f32 v[66:67], v[66:67], v[12:13] op_sel:[0,1] op_sel_hi:[1,1]
v_pk_mov_b32 v[114:115], v[18:19], v[18:19] op_sel:[0,0]
v_cndmask_b32 v130, v16, v17, s[68:69]
v_cndmask_b32 v131, v16, v17, s[70:71]
v_pk_add_f32 v[68:69], v[68:69], v[12:13] op_sel:[0,1] op_sel_hi:[1,1]
v_pk_mov_b32 v[116:117], v[18:19], v[18:19] op_sel:[0,0]
v_cndmask_b32 v132, v16, v17, s[72:73]
v_cndmask_b32 v133, v16, v17, s[74:75]
v_pk_add_f32 v[70:71], v[70:71], v[12:13] op_sel:[0,1] op_sel_hi:[1,1]
v_pk_mov_b32 v[118:119], v[18:19], v[18:19] op_sel:[0,0]
v_cndmask_b32 v134, v16, v17, s[76:77]
v_cndmask_b32 v135, v16, v17, s[78:79]
s_waitcnt lgkmcnt(0)
s_waitcnt lgkmcnt(3)
v_mfma_f32_32x32x16_bf16 v[72:87], v[32:35], v[26:29], v[120:135]
ds_read_b128 v[32:35], v6 offset:3072
v_exp_f32 v56, v56
v_exp_f32 v57, v57
v_exp_f32 v58, v58
v_exp_f32 v59, v59
v_cvt_pk_bf16_f32 v48, v56, v57
v_cvt_pk_bf16_f32 v49, v58, v59
s_waitcnt lgkmcnt(3)
ds_read_b128 v[44:47], v8 offset:25344
v_exp_f32 v60, v60
v_exp_f32 v61, v61
v_exp_f32 v62, v62
v_exp_f32 v63, v63
v_cvt_pk_bf16_f32 v50, v60, v61
v_cvt_pk_bf16_f32 v51, v62, v63
s_waitcnt lgkmcnt(3)
v_mfma_f32_32x32x8_bf16 v[72:87], v[36:37], v[30:31], v[72:87]
ds_read_b64 v[36:37], v7 offset:3072
v_exp_f32 v64, v64
v_exp_f32 v65, v65
v_exp_f32 v66, v66
v_exp_f32 v67, v67
v_cvt_pk_bf16_f32 v52, v64, v65
v_cvt_pk_bf16_f32 v53, v66, v67
s_waitcnt lgkmcnt(3)
v_mfma_f32_32x32x16_bf16 v[88:103], v[40:43], v[48:51], 0
ds_read_b128 v[40:43], v8 offset:0
v_exp_f32 v68, v68
v_exp_f32 v69, v69
v_exp_f32 v70, v70
v_exp_f32 v71, v71
v_cvt_pk_bf16_f32 v54, v68, v69
v_cvt_pk_bf16_f32 v55, v70, v71
s_waitcnt lgkmcnt(3)
v_mfma_f32_32x32x16_bf16 v[56:71], v[32:35], v[26:29], v[104:119]
ds_read_b128 v[32:35], v6 offset:6144
v_exp_f32 v72, v72
v_exp_f32 v73, v73
v_exp_f32 v74, v74
v_exp_f32 v75, v75
v_cvt_pk_bf16_f32 v48, v72, v73
v_cvt_pk_bf16_f32 v49, v74, v75
s_waitcnt lgkmcnt(3)
v_mfma_f32_32x32x16_bf16 v[88:103], v[44:47], v[52:55], v[88:103]
ds_read_b128 v[44:47], v8 offset:768
v_exp_f32 v76, v76
v_exp_f32 v77, v77
v_exp_f32 v78, v78
v_exp_f32 v79, v79
v_cvt_pk_bf16_f32 v50, v76, v77
v_cvt_pk_bf16_f32 v51, v78, v79
s_waitcnt lgkmcnt(3)
v_mfma_f32_32x32x8_bf16 v[56:71], v[36:37], v[30:31], v[56:71]
ds_read_b64 v[36:37], v7 offset:6144
v_exp_f32 v80, v80
v_exp_f32 v81, v81
v_exp_f32 v82, v82
v_exp_f32 v83, v83
v_cvt_pk_bf16_f32 v52, v80, v81
v_cvt_pk_bf16_f32 v53, v82, v83
s_waitcnt lgkmcnt(3)
v_mfma_f32_32x32x16_bf16 v[88:103], v[40:43], v[48:51], v[88:103]
ds_read_b128 v[40:43], v8 offset:3072
v_exp_f32 v84, v84
v_exp_f32 v85, v85
v_exp_f32 v86, v86
v_exp_f32 v87, v87
v_cvt_pk_bf16_f32 v54, v84, v85
v_cvt_pk_bf16_f32 v55, v86, v87
s_setprio 2
s_cmp_eq_u32 s31, 2
s_cbranch_scc1 K2_FIX2
K2_FIXR2:
s_waitcnt lgkmcnt(3)
v_mfma_f32_32x32x16_bf16 v[72:87], v[32:35], v[26:29], v[104:119]
ds_read_b128 v[32:35], v6 offset:9216
v_exp_f32 v56, v56
v_exp_f32 v57, v57
v_exp_f32 v58, v58
v_exp_f32 v59, v59
v_cvt_pk_bf16_f32 v48, v56, v57
v_cvt_pk_bf16_f32 v49, v58, v59
s_waitcnt lgkmcnt(3)
v_mfma_f32_32x32x16_bf16 v[88:103], v[44:47], v[52:55], v[88:103]
ds_read_b128 v[44:47], v8 offset:3840
v_exp_f32 v60, v60
v_exp_f32 v61, v61
v_exp_f32 v62, v62
v_exp_f32 v63, v63
v_cvt_pk_bf16_f32 v50, v60, v61
v_cvt_pk_bf16_f32 v51, v62, v63
s_waitcnt lgkmcnt(3)
v_mfma_f32_32x32x8_bf16 v[72:87], v[36:37], v[30:31], v[72:87]
ds_read_b64 v[36:37], v7 offset:9216
v_exp_f32 v64, v64
v_exp_f32 v65, v65
v_exp_f32 v66, v66
v_exp_f32 v67, v67
v_cvt_pk_bf16_f32 v52, v64, v65
v_cvt_pk_bf16_f32 v53, v66, v67
s_waitcnt lgkmcnt(3)
v_mfma_f32_32x32x16_bf16 v[88:103], v[40:43], v[48:51], v[88:103]
ds_read_b128 v[40:43], v8 offset:6144
v_exp_f32 v68, v68
v_exp_f32 v69, v69
v_exp_f32 v70, v70
v_exp_f32 v71, v71
v_cvt_pk_bf16_f32 v54, v68, v69
v_cvt_pk_bf16_f32 v55, v70, v71
s_cmp_eq_u32 s31, 3
s_cbranch_scc1 K2_FIX3
K2_FIXR3:
s_waitcnt lgkmcnt(3)
v_mfma_f32_32x32x16_bf16 v[56:71], v[32:35], v[26:29], v[104:119]
ds_read_b128 v[32:35], v6 offset:12288
v_exp_f32 v72, v72
v_exp_f32 v73, v73
v_exp_f32 v74, v74
v_exp_f32 v75, v75
v_cvt_pk_bf16_f32 v48, v72, v73
v_cvt_pk_bf16_f32 v49, v74, v75
s_waitcnt lgkmcnt(3)
v_mfma_f32_32x32x16_bf16 v[88:103], v[44:47], v[52:55], v[88:103]
ds_read_b128 v[44:47], v8 offset:6912
v_exp_f32 v76, v76
v_exp_f32 v77, v77
v_exp_f32 v78, v78
v_exp_f32 v79, v79
v_cvt_pk_bf16_f32 v50, v76, v77
v_cvt_pk_bf16_f32 v51, v78, v79
s_waitcnt lgkmcnt(3)
v_mfma_f32_32x32x8_bf16 v[56:71], v[36:37], v[30:31], v[56:71]
ds_read_b64 v[36:37], v7 offset:12288
v_exp_f32 v80, v80
v_exp_f32 v81, v81
v_exp_f32 v82, v82
v_exp_f32 v83, v83
v_cvt_pk_bf16_f32 v52, v80, v81
v_cvt_pk_bf16_f32 v53, v82, v83
s_waitcnt lgkmcnt(3)
v_mfma_f32_32x32x16_bf16 v[88:103], v[40:43], v[48:51], v[88:103]
ds_read_b128 v[40:43], v8 offset:9216
v_exp_f32 v84, v84
v_exp_f32 v85, v85
v_exp_f32 v86, v86
v_exp_f32 v87, v87
v_cvt_pk_bf16_f32 v54, v84, v85
v_cvt_pk_bf16_f32 v55, v86, v87
s_setprio 1
s_cmp_eq_u32 s31, 4
s_cbranch_scc1 K2_FIX4
K2_FIXR4:
s_waitcnt lgkmcnt(3)
v_mfma_f32_32x32x16_bf16 v[72:87], v[32:35], v[26:29], v[104:119]
ds_read_b128 v[32:35], v6 offset:15360
v_exp_f32 v56, v56
v_exp_f32 v57, v57
v_exp_f32 v58, v58
v_exp_f32 v59, v59
v_cvt_pk_bf16_f32 v48, v56, v57
v_cvt_pk_bf16_f32 v49, v58, v59
s_waitcnt lgkmcnt(3)
v_mfma_f32_32x32x16_bf16 v[88:103], v[44:47], v[52:55], v[88:103]
ds_read_b128 v[44:47], v8 offset:9984
v_exp_f32 v60, v60
v_exp_f32 v61, v61
v_exp_f32 v62, v62
v_exp_f32 v63, v63
v_cvt_pk_bf16_f32 v50, v60, v61
v_cvt_pk_bf16_f32 v51, v62, v63
s_waitcnt lgkmcnt(3)
v_mfma_f32_32x32x8_bf16 v[72:87], v[36:37], v[30:31], v[72:87]
ds_read_b64 v[36:37], v7 offset:15360
v_exp_f32 v64, v64
v_exp_f32 v65, v65
v_exp_f32 v66, v66
v_exp_f32 v67, v67
v_cvt_pk_bf16_f32 v52, v64, v65
v_cvt_pk_bf16_f32 v53, v66, v67
s_waitcnt lgkmcnt(3)
v_mfma_f32_32x32x16_bf16 v[88:103], v[40:43], v[48:51], v[88:103]
ds_read_b128 v[40:43], v8 offset:12288
v_exp_f32 v68, v68
v_exp_f32 v69, v69
v_exp_f32 v70, v70
v_exp_f32 v71, v71
v_cvt_pk_bf16_f32 v54, v68, v69
v_cvt_pk_bf16_f32 v55, v70, v71
s_cmp_eq_u32 s31, 5
s_cbranch_scc1 K2_FIX5
K2_FIXR5:
s_waitcnt lgkmcnt(3)
v_mfma_f32_32x32x16_bf16 v[56:71], v[32:35], v[26:29], v[104:119]
ds_read_b128 v[32:35], v6 offset:18432
v_exp_f32 v72, v72
v_exp_f32 v73, v73
v_exp_f32 v74, v74
v_exp_f32 v75, v75
v_cvt_pk_bf16_f32 v48, v72, v73
v_cvt_pk_bf16_f32 v49, v74, v75
s_waitcnt lgkmcnt(3)
v_mfma_f32_32x32x16_bf16 v[88:103], v[44:47], v[52:55], v[88:103]
ds_read_b128 v[44:47], v8 offset:13056
v_exp_f32 v76, v76
v_exp_f32 v77, v77
v_exp_f32 v78, v78
v_exp_f32 v79, v79
v_cvt_pk_bf16_f32 v50, v76, v77
v_cvt_pk_bf16_f32 v51, v78, v79
s_waitcnt lgkmcnt(3)
v_mfma_f32_32x32x8_bf16 v[56:71], v[36:37], v[30:31], v[56:71]
ds_read_b64 v[36:37], v7 offset:18432
v_exp_f32 v80, v80
v_exp_f32 v81, v81
v_exp_f32 v82, v82
v_exp_f32 v83, v83
v_cvt_pk_bf16_f32 v52, v80, v81
v_cvt_pk_bf16_f32 v53, v82, v83
s_waitcnt lgkmcnt(3)
v_mfma_f32_32x32x16_bf16 v[88:103], v[40:43], v[48:51], v[88:103]
ds_read_b128 v[40:43], v8 offset:15360
v_exp_f32 v84, v84
v_exp_f32 v85, v85
v_exp_f32 v86, v86
v_exp_f32 v87, v87
v_cvt_pk_bf16_f32 v54, v84, v85
v_cvt_pk_bf16_f32 v55, v86, v87
s_setprio 0
s_cmp_eq_u32 s31, 6
s_cbranch_scc1 K2_FIX6
K2_FIXR6:
s_waitcnt lgkmcnt(3)
v_mfma_f32_32x32x16_bf16 v[72:87], v[32:35], v[26:29], v[104:119]
ds_read_b128 v[32:35], v6 offset:21504
v_exp_f32 v56, v56
v_exp_f32 v57, v57
v_exp_f32 v58, v58
v_exp_f32 v59, v59
v_cvt_pk_bf16_f32 v48, v56, v57
v_cvt_pk_bf16_f32 v49, v58, v59
s_waitcnt lgkmcnt(3)
v_mfma_f32_32x32x16_bf16 v[88:103], v[44:47], v[52:55], v[88:103]
ds_read_b128 v[44:47], v8 offset:16128
v_exp_f32 v60, v60
v_exp_f32 v61, v61
v_exp_f32 v62, v62
v_exp_f32 v63, v63
v_cvt_pk_bf16_f32 v50, v60, v61
v_cvt_pk_bf16_f32 v51, v62, v63
s_waitcnt lgkmcnt(3)
v_mfma_f32_32x32x8_bf16 v[72:87], v[36:37], v[30:31], v[72:87]
ds_read_b64 v[36:37], v7 offset:21504
v_exp_f32 v64, v64
v_exp_f32 v65, v65
v_exp_f32 v66, v66
v_exp_f32 v67, v67
v_cvt_pk_bf16_f32 v52, v64, v65
v_cvt_pk_bf16_f32 v53, v66, v67
s_waitcnt lgkmcnt(3)
v_mfma_f32_32x32x16_bf16 v[88:103], v[40:43], v[48:51], v[88:103]
ds_read_b128 v[40:43], v8 offset:18432
v_exp_f32 v68, v68
v_exp_f32 v69, v69
v_exp_f32 v70, v70
v_exp_f32 v71, v71
v_cvt_pk_bf16_f32 v54, v68, v69
v_cvt_pk_bf16_f32 v55, v70, v71
s_cmp_eq_u32 s31, 7
s_cbranch_scc1 K2_FIX7
K2_FIXR7:
s_waitcnt lgkmcnt(3)
v_mfma_f32_32x32x16_bf16 v[56:71], v[32:35], v[26:29], v[104:119]
v_exp_f32 v72, v72
v_exp_f32 v73, v73
v_exp_f32 v74, v74
v_exp_f32 v75, v75
v_cvt_pk_bf16_f32 v48, v72, v73
v_cvt_pk_bf16_f32 v49, v74, v75
s_waitcnt lgkmcnt(0)
v_mfma_f32_32x32x16_bf16 v[88:103], v[44:47], v[52:55], v[88:103]
ds_read_b128 v[44:47], v8 offset:19200
v_exp_f32 v76, v76
v_exp_f32 v77, v77
v_exp_f32 v78, v78
v_exp_f32 v79, v79
v_cvt_pk_bf16_f32 v50, v76, v77
v_cvt_pk_bf16_f32 v51, v78, v79
s_waitcnt lgkmcnt(1)
v_mfma_f32_32x32x8_bf16 v[56:71], v[36:37], v[30:31], v[56:71]
v_exp_f32 v80, v80
v_exp_f32 v81, v81
v_exp_f32 v82, v82
v_exp_f32 v83, v83
v_cvt_pk_bf16_f32 v52, v80, v81
v_cvt_pk_bf16_f32 v53, v82, v83
s_waitcnt lgkmcnt(1)
v_mfma_f32_32x32x16_bf16 v[88:103], v[40:43], v[48:51], v[88:103]
ds_read_b128 v[40:43], v8 offset:21504
v_exp_f32 v84, v84
v_exp_f32 v85, v85
v_exp_f32 v86, v86
v_exp_f32 v87, v87
v_cvt_pk_bf16_f32 v54, v84, v85
v_cvt_pk_bf16_f32 v55, v86, v87
v_exp_f32 v56, v56
v_exp_f32 v57, v57
v_exp_f32 v58, v58
v_exp_f32 v59, v59
v_cvt_pk_bf16_f32 v48, v56, v57
v_cvt_pk_bf16_f32 v49, v58, v59
s_waitcnt lgkmcnt(0)
v_mfma_f32_32x32x16_bf16 v[88:103], v[44:47], v[52:55], v[88:103]
ds_read_b128 v[44:47], v8 offset:22272
v_exp_f32 v60, v60
v_exp_f32 v61, v61
v_exp_f32 v62, v62
v_exp_f32 v63, v63
v_cvt_pk_bf16_f32 v50, v60, v61
v_cvt_pk_bf16_f32 v51, v62, v63
v_exp_f32 v64, v64
v_exp_f32 v65, v65
v_exp_f32 v66, v66
v_exp_f32 v67, v67
v_cvt_pk_bf16_f32 v52, v64, v65
v_cvt_pk_bf16_f32 v53, v66, v67
s_waitcnt lgkmcnt(1)
v_mfma_f32_32x32x16_bf16 v[88:103], v[40:43], v[48:51], v[88:103]
v_exp_f32 v68, v68
v_exp_f32 v69, v69
v_exp_f32 v70, v70
v_exp_f32 v71, v71
v_cvt_pk_bf16_f32 v54, v68, v69
v_cvt_pk_bf16_f32 v55, v70, v71
s_waitcnt lgkmcnt(0)
v_mfma_f32_32x32x16_bf16 v[88:103], v[44:47], v[52:55], v[88:103]
s_nop 7
s_nop 7
v_cmp_eq_u32 vcc, 0, v1
s_nop 1
v_cndmask_b32 v14, v96, v100, vcc
v_mov_b32 v16, v14
v_mov_b32 v17, 0
v_pk_fma_f32 v[16:17], v[88:89], 0, v[16:17]
v_pk_fma_f32 v[16:17], v[90:91], 0, v[16:17]
v_pk_fma_f32 v[16:17], v[92:93], 0, v[16:17]
v_pk_fma_f32 v[16:17], v[94:95], 0, v[16:17]
v_pk_fma_f32 v[16:17], v[96:97], 0, v[16:17]
v_pk_fma_f32 v[16:17], v[98:99], 0, v[16:17]
v_add_f32 v15, v16, v17
v_cmp_gt_f32 vcc, s33, v15
s_nop 4
s_cmp_eq_u64 vcc, -1
s_cbranch_scc1 K2_OKB
s_sub_u32 s40, s15, 8
s_cmp_lt_u32 s15, 8
s_cselect_b32 s40, 0, s40
s_add_u32 s41, s15, 1
s_mov_b32 s42, s17
v_and_b32 v16, 31, v0
s_lshl_b32 s3, s15, 5
v_add_u32 v16, s3, v16
v_lshlrev_b32 v17, 2, v1
v_sub_u32 v16, v16, v17
v_mov_b32 v14, 0xf149f2ca
s_mov_b32 s43, s40
K2_SLB_1:
s_mul_i32 s44, s43, 3072
s_add_u32 s44, s44, s42
buffer_load_dwordx4 v[32:35], v3, s[8:11], s44 offen
buffer_load_dwordx2 v[36:37], v4, s[8:11], s44 offen
s_waitcnt vmcnt(0)
v_mfma_f32_32x32x16_bf16 v[56:71], v[32:35], v[26:29], 0
s_nop 7
s_nop 7
v_mfma_f32_32x32x8_bf16 v[56:71], v[36:37], v[30:31], v[56:71]
s_nop 7
s_nop 7
s_lshl_b32 s45, s43, 5
v_subrev_u32 v17, s45, v16
v_mov_b32 v19, 0xf149f2ca
s_movk_i32 s46, 0x100
v_subrev_u32 v18, 0, v17
v_cmp_gt_u32 vcc, s46, v18
s_nop 1
v_cndmask_b32 v56, v19, v56, vcc
v_subrev_u32 v18, 1, v17
v_cmp_gt_u32 vcc, s46, v18
s_nop 1
v_cndmask_b32 v57, v19, v57, vcc
v_subrev_u32 v18, 2, v17
v_cmp_gt_u32 vcc, s46, v18
s_nop 1
v_cndmask_b32 v58, v19, v58, vcc
v_subrev_u32 v18, 3, v17
v_cmp_gt_u32 vcc, s46, v18
s_nop 1
v_cndmask_b32 v59, v19, v59, vcc
v_subrev_u32 v18, 8, v17
v_cmp_gt_u32 vcc, s46, v18
s_nop 1
v_cndmask_b32 v60, v19, v60, vcc
v_subrev_u32 v18, 9, v17
v_cmp_gt_u32 vcc, s46, v18
s_nop 1
v_cndmask_b32 v61, v19, v61, vcc
v_subrev_u32 v18, 10, v17
v_cmp_gt_u32 vcc, s46, v18
s_nop 1
v_cndmask_b32 v62, v19, v62, vcc
v_subrev_u32 v18, 11, v17
v_cmp_gt_u32 vcc, s46, v18
s_nop 1
v_cndmask_b32 v63, v19, v63, vcc
v_subrev_u32 v18, 16, v17
v_cmp_gt_u32 vcc, s46, v18
s_nop 1
v_cndmask_b32 v64, v19, v64, vcc
v_subrev_u32 v18, 17, v17
v_cmp_gt_u32 vcc, s46, v18
s_nop 1
v_cndmask_b32 v65, v19, v65, vcc
v_subrev_u32 v18, 18, v17
v_cmp_gt_u32 vcc, s46, v18
s_nop 1
v_cndmask_b32 v66, v19, v66, vcc
v_subrev_u32 v18, 19, v17
v_cmp_gt_u32 vcc, s46, v18
s_nop 1
v_cndmask_b32 v67, v19, v67, vcc
v_subrev_u32 v18, 24, v17
v_cmp_gt_u32 vcc, s46, v18
s_nop 1
v_cndmask_b32 v68, v19, v68, vcc
v_subrev_u32 v18, 25, v17
v_cmp_gt_u32 vcc, s46, v18
s_nop 1
v_cndmask_b32 v69, v19, v69, vcc
v_subrev_u32 v18, 26, v17
v_cmp_gt_u32 vcc, s46, v18
s_nop 1
v_cndmask_b32 v70, v19, v70, vcc
v_subrev_u32 v18, 27, v17
v_cmp_gt_u32 vcc, s46, v18
s_nop 1
v_cndmask_b32 v71, v19, v71, vcc
v_max_f32 v14, v14, v56
v_max_f32 v14, v14, v57
v_max_f32 v14, v14, v58
v_max_f32 v14, v14, v59
v_max_f32 v14, v14, v60
v_max_f32 v14, v14, v61
v_max_f32 v14, v14, v62
v_max_f32 v14, v14, v63
v_max_f32 v14, v14, v64
v_max_f32 v14, v14, v65
v_max_f32 v14, v14, v66
v_max_f32 v14, v14, v67
v_max_f32 v14, v14, v68
v_max_f32 v14, v14, v69
v_max_f32 v14, v14, v70
v_max_f32 v14, v14, v71
s_add_u32 s43, s43, 1
s_cmp_lt_u32 s43, s41
s_cbranch_scc1 K2_SLB_1
v_mov_b32 v15, v14
s_nop 1
v_permlane32_swap_b32 v14, v15
s_nop 1
v_max_f32 v14, v14, v15
v_mov_b32 v88, 0
v_mov_b32 v89, 0
v_mov_b32 v90, 0
v_mov_b32 v91, 0
v_mov_b32 v92, 0
v_mov_b32 v93, 0
v_mov_b32 v94, 0
v_mov_b32 v95, 0
v_mov_b32 v96, 0
v_mov_b32 v97, 0
v_mov_b32 v98, 0
v_mov_b32 v99, 0
v_mov_b32 v100, 0
v_mov_b32 v101, 0
v_mov_b32 v102, 0
v_mov_b32 v103, 0
s_mov_b32 s43, s40
K2_SLB_2:
s_mul_i32 s44, s43, 3072
s_add_u32 s44, s44, s42
buffer_load_dwordx4 v[32:35], v3, s[8:11], s44 offen
buffer_load_dwordx2 v[36:37], v4, s[8:11], s44 offen
buffer_load_dwordx4 v[40:43], v5, s[8:11], s44 offen
buffer_load_dwordx4 v[44:47], v5, s[8:11], s44 offen offset:768
s_waitcnt vmcnt(0)
v_mfma_f32_32x32x16_bf16 v[56:71], v[32:35], v[26:29], 0
s_nop 7
s_nop 7
v_mfma_f32_32x32x8_bf16 v[56:71], v[36:37], v[30:31], v[56:71]
s_nop 7
s_nop 7
s_lshl_b32 s45, s43, 5
v_subrev_u32 v17, s45, v16
v_mov_b32 v19, 0xf149f2ca
s_movk_i32 s46, 0x100
v_subrev_u32 v18, 0, v17
v_cmp_gt_u32 vcc, s46, v18
s_nop 1
v_cndmask_b32 v56, v19, v56, vcc
v_subrev_u32 v18, 1, v17
v_cmp_gt_u32 vcc, s46, v18
s_nop 1
v_cndmask_b32 v57, v19, v57, vcc
v_subrev_u32 v18, 2, v17
v_cmp_gt_u32 vcc, s46, v18
s_nop 1
v_cndmask_b32 v58, v19, v58, vcc
v_subrev_u32 v18, 3, v17
v_cmp_gt_u32 vcc, s46, v18
s_nop 1
v_cndmask_b32 v59, v19, v59, vcc
v_subrev_u32 v18, 8, v17
v_cmp_gt_u32 vcc, s46, v18
s_nop 1
v_cndmask_b32 v60, v19, v60, vcc
v_subrev_u32 v18, 9, v17
v_cmp_gt_u32 vcc, s46, v18
s_nop 1
v_cndmask_b32 v61, v19, v61, vcc
v_subrev_u32 v18, 10, v17
v_cmp_gt_u32 vcc, s46, v18
s_nop 1
v_cndmask_b32 v62, v19, v62, vcc
v_subrev_u32 v18, 11, v17
v_cmp_gt_u32 vcc, s46, v18
s_nop 1
v_cndmask_b32 v63, v19, v63, vcc
v_subrev_u32 v18, 16, v17
v_cmp_gt_u32 vcc, s46, v18
s_nop 1
v_cndmask_b32 v64, v19, v64, vcc
v_subrev_u32 v18, 17, v17
v_cmp_gt_u32 vcc, s46, v18
s_nop 1
v_cndmask_b32 v65, v19, v65, vcc
v_subrev_u32 v18, 18, v17
v_cmp_gt_u32 vcc, s46, v18
s_nop 1
v_cndmask_b32 v66, v19, v66, vcc
v_subrev_u32 v18, 19, v17
v_cmp_gt_u32 vcc, s46, v18
s_nop 1
v_cndmask_b32 v67, v19, v67, vcc
v_subrev_u32 v18, 24, v17
v_cmp_gt_u32 vcc, s46, v18
s_nop 1
v_cndmask_b32 v68, v19, v68, vcc
v_subrev_u32 v18, 25, v17
v_cmp_gt_u32 vcc, s46, v18
s_nop 1
v_cndmask_b32 v69, v19, v69, vcc
v_subrev_u32 v18, 26, v17
v_cmp_gt_u32 vcc, s46, v18
s_nop 1
v_cndmask_b32 v70, v19, v70, vcc
v_subrev_u32 v18, 27, v17
v_cmp_gt_u32 vcc, s46, v18
s_nop 1
v_cndmask_b32 v71, v19, v71, vcc
v_sub_f32 v56, v56, v14
v_exp_f32 v56, v56
v_sub_f32 v57, v57, v14
v_exp_f32 v57, v57
v_sub_f32 v58, v58, v14
v_exp_f32 v58, v58
v_sub_f32 v59, v59, v14
v_exp_f32 v59, v59
v_sub_f32 v60, v60, v14
v_exp_f32 v60, v60
v_sub_f32 v61, v61, v14
v_exp_f32 v61, v61
v_sub_f32 v62, v62, v14
v_exp_f32 v62, v62
v_sub_f32 v63, v63, v14
v_exp_f32 v63, v63
v_sub_f32 v64, v64, v14
v_exp_f32 v64, v64
v_sub_f32 v65, v65, v14
v_exp_f32 v65, v65
v_sub_f32 v66, v66, v14
v_exp_f32 v66, v66
v_sub_f32 v67, v67, v14
v_exp_f32 v67, v67
v_sub_f32 v68, v68, v14
v_exp_f32 v68, v68
v_sub_f32 v69, v69, v14
v_exp_f32 v69, v69
v_sub_f32 v70, v70, v14
v_exp_f32 v70, v70
v_sub_f32 v71, v71, v14
v_exp_f32 v71, v71
s_nop 0
v_cvt_pk_bf16_f32 v48, v56, v57
v_cvt_pk_bf16_f32 v49, v58, v59
v_cvt_pk_bf16_f32 v50, v60, v61
v_cvt_pk_bf16_f32 v51, v62, v63
v_cvt_pk_bf16_f32 v52, v64, v65
v_cvt_pk_bf16_f32 v53, v66, v67
v_cvt_pk_bf16_f32 v54, v68, v69
v_cvt_pk_bf16_f32 v55, v70, v71
s_nop 1
v_mfma_f32_32x32x16_bf16 v[88:103], v[40:43], v[48:51], v[88:103]
s_nop 7
s_nop 7
v_mfma_f32_32x32x16_bf16 v[88:103], v[44:47], v[52:55], v[88:103]
s_nop 7
s_nop 7
s_add_u32 s43, s43, 1
s_cmp_lt_u32 s43, s41
s_cbranch_scc1 K2_SLB_2
v_cmp_eq_u32 vcc, 0, v1
s_nop 1
v_cndmask_b32 v14, v96, v100, vcc
K2_OKB:
v_rcp_f32 v14, v14
v_sub_f32 v15, 1.0, v12
v_mul_f32 v14, v14, v15
v_pk_mul_f32 v[88:89], v[88:89], v[14:15] op_sel:[0,0] op_sel_hi:[1,0]
v_pk_mul_f32 v[90:91], v[90:91], v[14:15] op_sel:[0,0] op_sel_hi:[1,0]
v_pk_mul_f32 v[92:93], v[92:93], v[14:15] op_sel:[0,0] op_sel_hi:[1,0]
v_pk_mul_f32 v[94:95], v[94:95], v[14:15] op_sel:[0,0] op_sel_hi:[1,0]
v_pk_mul_f32 v[96:97], v[96:97], v[14:15] op_sel:[0,0] op_sel_hi:[1,0]
v_pk_mul_f32 v[98:99], v[98:99], v[14:15] op_sel:[0,0] op_sel_hi:[1,0]
s_mov_b32 s5, 11816960
v_cvt_pk_bf16_f32 v48, v88, v89
v_cvt_pk_bf16_f32 v49, v90, v91
v_cvt_pk_bf16_f32 v50, v92, v93
v_cvt_pk_bf16_f32 v51, v94, v95
v_cvt_pk_bf16_f32 v52, v96, v97
v_cvt_pk_bf16_f32 v53, v98, v99
v_cndmask_b32 v72, v48, v50, s[80:81]
v_cndmask_b32 v73, v49, v51, s[80:81]
buffer_store_dwordx2 v[72:73], v136, s[8:11], s5 offen
v_cndmask_b32 v74, v50, v52, s[80:81]
v_cndmask_b32 v75, v51, v53, s[80:81]
buffer_store_dwordx2 v[74:75], v137, s[8:11], s5 offen
v_cndmask_b32 v76, v52, v48, s[80:81]
v_cndmask_b32 v77, v53, v49, s[80:81]
s_mov_b32 exec_hi, 0
buffer_store_dwordx2 v[76:77], v138, s[8:11], s5 offen
s_mov_b64 exec, -1
s_endpgm
K2_PROD:
s_sub_u32 s19, s14, 8
v_lshlrev_b32 v2, 4, v0
s_mul_i32 s18, s19, 6144
s_add_u32 s20, s18, 5267456
s_add_u32 s22, s18, 24576
s_setprio 3
s_barrier
s_add_u32 m0, s22, 0
s_add_u32 s3, s20, 0
buffer_load_dwordx4 v2, s[8:11], s3 offen lds
s_add_u32 m0, s22, 1024
s_add_u32 s3, s20, 1024
buffer_load_dwordx4 v2, s[8:11], s3 offen lds
s_add_u32 m0, s22, 2048
s_add_u32 s3, s20, 2048
buffer_load_dwordx4 v2, s[8:11], s3 offen lds
s_add_u32 m0, s22, 3072
s_add_u32 s3, s20, 3072
buffer_load_dwordx4 v2, s[8:11], s3 offen lds
s_add_u32 m0, s22, 4096
s_add_u32 s3, s20, 4096
buffer_load_dwordx4 v2, s[8:11], s3 offen lds
s_add_u32 m0, s22, 5120
s_add_u32 s3, s20, 5120
buffer_load_dwordx4 v2, s[8:11], s3 offen lds
s_add_u32 s20, s20, 24576
s_add_u32 s22, s22, 24576
s_lshr_b32 s17, s12, 1
s_lshl_b32 s17, s17, 1
s_mul_i32 s17, s17, 196608
s_add_u32 s17, s17, 5439488
s_mul_i32 s24, s19, 3
s_lshl_b32 s25, s13, 2
s_add_u32 s25, s25, s24
s_mul_i32 s24, s24, 3072
s_add_u32 s24, s24, 73728
s_add_u32 s4, s25, 0
s_sub_i32 s4, s4, 8
s_max_i32 s4, s4, 0
s_mul_i32 s4, s4, 3072
s_add_u32 s26, s4, s17
s_add_u32 m0, s24, 0
s_add_u32 s3, s26, 0
buffer_load_dwordx4 v2, s[8:11], s3 offen lds
s_add_u32 m0, s24, 1024
s_add_u32 s3, s26, 1024
buffer_load_dwordx4 v2, s[8:11], s3 offen lds
s_add_u32 m0, s24, 2048
s_add_u32 s3, s26, 2048
buffer_load_dwordx4 v2, s[8:11], s3 offen lds
s_add_u32 m0, s24, 36864
s_add_u32 s3, s26, 196608
buffer_load_dwordx4 v2, s[8:11], s3 offen lds
s_add_u32 m0, s24, 37888
s_add_u32 s3, s26, 197632
buffer_load_dwordx4 v2, s[8:11], s3 offen lds
s_add_u32 m0, s24, 38912
s_add_u32 s3, s26, 198656
buffer_load_dwordx4 v2, s[8:11], s3 offen lds
s_add_u32 s4, s25, 1
s_sub_i32 s4, s4, 8
s_max_i32 s4, s4, 0
s_mul_i32 s4, s4, 3072
s_add_u32 s26, s4, s17
s_add_u32 m0, s24, 3072
s_add_u32 s3, s26, 0
buffer_load_dwordx4 v2, s[8:11], s3 offen lds
s_add_u32 m0, s24, 4096
s_add_u32 s3, s26, 1024
buffer_load_dwordx4 v2, s[8:11], s3 offen lds
s_add_u32 m0, s24, 5120
s_add_u32 s3, s26, 2048
buffer_load_dwordx4 v2, s[8:11], s3 offen lds
s_add_u32 m0, s24, 39936
s_add_u32 s3, s26, 196608
buffer_load_dwordx4 v2, s[8:11], s3 offen lds
s_add_u32 m0, s24, 40960
s_add_u32 s3, s26, 197632
buffer_load_dwordx4 v2, s[8:11], s3 offen lds
s_add_u32 m0, s24, 41984
s_add_u32 s3, s26, 198656
buffer_load_dwordx4 v2, s[8:11], s3 offen lds
s_add_u32 s4, s25, 2
s_sub_i32 s4, s4, 8
s_max_i32 s4, s4, 0
s_mul_i32 s4, s4, 3072
s_add_u32 s26, s4, s17
s_add_u32 m0, s24, 6144
s_add_u32 s3, s26, 0
buffer_load_dwordx4 v2, s[8:11], s3 offen lds
s_add_u32 m0, s24, 7168
s_add_u32 s3, s26, 1024
buffer_load_dwordx4 v2, s[8:11], s3 offen lds
s_add_u32 m0, s24, 8192
s_add_u32 s3, s26, 2048
buffer_load_dwordx4 v2, s[8:11], s3 offen lds
s_add_u32 m0, s24, 43008
s_add_u32 s3, s26, 196608
buffer_load_dwordx4 v2, s[8:11], s3 offen lds
s_add_u32 m0, s24, 44032
s_add_u32 s3, s26, 197632
buffer_load_dwordx4 v2, s[8:11], s3 offen lds
s_add_u32 m0, s24, 45056
s_add_u32 s3, s26, 198656
buffer_load_dwordx4 v2, s[8:11], s3 offen lds
s_waitcnt vmcnt(18)
s_barrier
s_mov_b32 s16, 0
K2_PL:
s_cmp_lt_u32 s16, 6
s_cbranch_scc0 K2_PSK
s_add_u32 m0, s22, 0
s_add_u32 s3, s20, 0
buffer_load_dwordx4 v2, s[8:11], s3 offen lds
s_add_u32 m0, s22, 1024
s_add_u32 s3, s20, 1024
buffer_load_dwordx4 v2, s[8:11], s3 offen lds
s_add_u32 m0, s22, 2048
s_add_u32 s3, s20, 2048
buffer_load_dwordx4 v2, s[8:11], s3 offen lds
s_add_u32 m0, s22, 3072
s_add_u32 s3, s20, 3072
buffer_load_dwordx4 v2, s[8:11], s3 offen lds
s_add_u32 m0, s22, 4096
s_add_u32 s3, s20, 4096
buffer_load_dwordx4 v2, s[8:11], s3 offen lds
s_add_u32 m0, s22, 5120
s_add_u32 s3, s20, 5120
buffer_load_dwordx4 v2, s[8:11], s3 offen lds
K2_PSK:
s_add_u32 s20, s20, 24576
s_add_u32 s22, s22, 24576
s_add_u32 s3, s18, 73728
s_cmp_eq_u32 s22, s3
s_cselect_b32 s22, s18, s22
s_add_u32 s16, s16, 1
s_cmp_lt_u32 s16, 8
s_cbranch_scc0 K2_PDONE
s_waitcnt vmcnt(0)
s_barrier
s_branch K2_PL
K2_PDONE:
s_lshl_b32 s28, s2, 2
s_add_u32 s28, s28, s19
s_cmp_ge_u32 s28, 800
s_cbranch_scc1 K2_PNOPF
s_load_dwordx2 s[30:31], s[0:1], 32
s_load_dwordx2 s[34:35], s[0:1], 56
s_mul_i32 s29, s28, 52429
s_lshr_b32 s29, s29, 18
s_mul_i32 s3, s29, 5
s_sub_u32 s3, s28, s3
s_lshl_b32 s3, s3, 7
s_lshr_b32 s4, s29, 3
s_and_b32 s5, s29, 7
s_mul_i32 s5, s5, 160
s_sub_u32 s6, s4, 10
s_cmp_ge_u32 s4, 10
s_cselect_b32 s4, s6, s4
s_waitcnt lgkmcnt(0)
s_cselect_b32 s30, s34, s30
s_cselect_b32 s31, s35, s31
s_mul_i32 s4, s4, 81920
s_add_u32 s44, s4, s5
s_lshl_b32 s45, s28, 11
s_add_u32 s45, s45, 20971520
s_mov_b32 s36, s30
s_and_b32 s37, s31, 0xffff
s_mov_b32 s38, 819200
s_mov_b32 s39, 0x20000
v_add_u32 v4, s3, v0
v_add_u32 v4, 0, v4
v_mul_u32_u24 v5, 52429, v4
v_lshrrev_b32 v5, 19, v5
v_mul_u32_u24 v6, 10, v5
v_sub_u32 v6, v4, v6
v_bfe_u32 v7, v5, 2, 2
v_bfe_u32 v16, v5, 4, 1
v_and_b32 v5, 0x23, v5
v_lshl_or_b32 v5, v7, 3, v5
v_lshl_or_b32 v5, v16, 2, v5
v_mul_u32_u24 v5, 1280, v5
v_lshl_add_u32 v5, v6, 4, v5
buffer_load_dwordx4 v[8:11], v5, s[36:39], s44 offen
v_add_u32 v4, s3, v0
v_add_u32 v4, 64, v4
v_mul_u32_u24 v5, 52429, v4
v_lshrrev_b32 v5, 19, v5
v_mul_u32_u24 v6, 10, v5
v_sub_u32 v6, v4, v6
v_bfe_u32 v7, v5, 2, 2
v_bfe_u32 v16, v5, 4, 1
v_and_b32 v5, 0x23, v5
v_lshl_or_b32 v5, v7, 3, v5
v_lshl_or_b32 v5, v16, 2, v5
v_mul_u32_u24 v5, 1280, v5
v_lshl_add_u32 v5, v6, 4, v5
buffer_load_dwordx4 v[12:15], v5, s[36:39], s44 offen
s_waitcnt vmcnt(1)
buffer_store_dwordx4 v[8:11], v2, s[8:11], s45 offen sc0 sc1
s_waitcnt vmcnt(1)
buffer_store_dwordx4 v[12:15], v2, s[8:11], s45 offen offset:1024 sc0 sc1
s_waitcnt vmcnt(0)
K2_PNOPF:
s_endpgm
K2_FIX2:
v_mov_b32 v104, v13
v_mov_b32 v105, v13
v_mov_b32 v106, v13
v_mov_b32 v107, v13
v_mov_b32 v108, v13
v_mov_b32 v109, v13
v_mov_b32 v110, v13
v_mov_b32 v111, v13
v_mov_b32 v112, v13
v_mov_b32 v113, v13
v_mov_b32 v114, v13
v_mov_b32 v115, v13
v_mov_b32 v116, v13
v_mov_b32 v117, v13
v_mov_b32 v118, v13
v_mov_b32 v119, v13
s_nop 1
s_branch K2_FIXR2
K2_FIX3:
v_mov_b32 v104, v13
v_mov_b32 v105, v13
v_mov_b32 v106, v13
v_mov_b32 v107, v13
v_mov_b32 v108, v13
v_mov_b32 v109, v13
v_mov_b32 v110, v13
v_mov_b32 v111, v13
v_mov_b32 v112, v13
v_mov_b32 v113, v13
v_mov_b32 v114, v13
v_mov_b32 v115, v13
v_mov_b32 v116, v13
v_mov_b32 v117, v13
v_mov_b32 v118, v13
v_mov_b32 v119, v13
s_nop 1
s_branch K2_FIXR3
K2_FIX4:
v_mov_b32 v104, v13
v_mov_b32 v105, v13
v_mov_b32 v106, v13
v_mov_b32 v107, v13
v_mov_b32 v108, v13
v_mov_b32 v109, v13
v_mov_b32 v110, v13
v_mov_b32 v111, v13
v_mov_b32 v112, v13
v_mov_b32 v113, v13
v_mov_b32 v114, v13
v_mov_b32 v115, v13
v_mov_b32 v116, v13
v_mov_b32 v117, v13
v_mov_b32 v118, v13
v_mov_b32 v119, v13
s_nop 1
s_branch K2_FIXR4
K2_FIX5:
v_mov_b32 v104, v13
v_mov_b32 v105, v13
v_mov_b32 v106, v13
v_mov_b32 v107, v13
v_mov_b32 v108, v13
v_mov_b32 v109, v13
v_mov_b32 v110, v13
v_mov_b32 v111, v13
v_mov_b32 v112, v13
v_mov_b32 v113, v13
v_mov_b32 v114, v13
v_mov_b32 v115, v13
v_mov_b32 v116, v13
v_mov_b32 v117, v13
v_mov_b32 v118, v13
v_mov_b32 v119, v13
s_nop 1
s_branch K2_FIXR5
K2_FIX6:
v_mov_b32 v104, v13
v_mov_b32 v105, v13
v_mov_b32 v106, v13
v_mov_b32 v107, v13
v_mov_b32 v108, v13
v_mov_b32 v109, v13
v_mov_b32 v110, v13
v_mov_b32 v111, v13
v_mov_b32 v112, v13
v_mov_b32 v113, v13
v_mov_b32 v114, v13
v_mov_b32 v115, v13
v_mov_b32 v116, v13
v_mov_b32 v117, v13
v_mov_b32 v118, v13
v_mov_b32 v119, v13
s_nop 1
s_branch K2_FIXR6
K2_FIX7:
v_mov_b32 v104, v13
v_mov_b32 v105, v13
v_mov_b32 v106, v13
v_mov_b32 v107, v13
v_mov_b32 v108, v13
v_mov_b32 v109, v13
v_mov_b32 v110, v13
v_mov_b32 v111, v13
v_mov_b32 v112, v13
v_mov_b32 v113, v13
v_mov_b32 v114, v13
v_mov_b32 v115, v13
v_mov_b32 v116, v13
v_mov_b32 v117, v13
v_mov_b32 v118, v13
v_mov_b32 v119, v13
s_nop 1
s_branch K2_FIXR7
K2_END:
s_endpgm
.globl oproj_kernel
.p2align 8
.type oproj_kernel,@function
oproj_kernel:
s_cmp_ge_u32 s2, 256
s_cbranch_scc1 K3_END
s_load_dwordx2 s[4:5], s[0:1], 32
s_load_dwordx2 s[6:7], s[0:1], 56
s_load_dwordx2 s[20:21], s[0:1], 72
s_load_dwordx2 s[22:23], s[0:1], 88
s_and_b32 s3, s2, 7
s_lshr_b32 s24, s2, 3
s_lshr_b32 s25, s3, 1
s_lshl_b32 s25, s25, 3
s_and_b32 s26, s24, 7
s_add_u32 s25, s25, s26
s_and_b32 s26, s3, 1
s_lshl_b32 s26, s26, 2
s_lshr_b32 s27, s24, 3
s_add_u32 s26, s26, s27
v_lshrrev_b32 v1, 6, v0
v_and_b32 v0, 63, v0
s_nop 0
v_readfirstlane_b32 s34, v1
s_and_b32 s27, s34, 3
s_waitcnt lgkmcnt(0)
s_lshr_b32 s28, s27, 1
s_and_b32 s29, s27, 1
s_cmp_eq_u32 s28, 0
s_cselect_b32 s8, s4, s6
s_cselect_b32 s9, s5, s7
s_and_b32 s9, s9, 0xffff
s_mov_b32 s10, 819200
s_mov_b32 s11, 0x20000
s_and_b32 s35, s24, 7
s_lshr_b32 s3, s24, 3
s_mul_i32 s3, s3, 3
s_add_u32 s35, s35, s3
s_sub_u32 s3, s35, 10
s_cmp_ge_u32 s35, 10
s_cselect_b32 s35, s3, s35
s_mov_b32 s35, 0
s_cmp_ge_u32 s34, 4
s_cbranch_scc1 K3_PROD
s_mov_b32 s12, s22
s_and_b32 s13, s23, 0xffff
s_mov_b32 s14, 0x10000000
s_mov_b32 s15, 0x20000
s_mov_b32 s16, s20
s_and_b32 s17, s21, 0xffff
s_mov_b32 s18, 2621440
s_mov_b32 s19, 0x20000
s_mul_i32 s30, s26, 160
s_lshl_b32 s3, s25, 2
s_lshl_b32 s4, s29, 1
s_add_u32 s31, s3, s4
s_mul_i32 s32, s31, 40960
s_mul_i32 s4, s28, 20480
s_add_u32 s32, s32, s4
s_add_u32 s32, s32, 11796480
v_lshlrev_b32 v7, 4, v0
s_mul_i32 s33, s27, 5120
v_lshrrev_b32 v12, 4, v0
v_bfe_u32 v13, v0, 2, 2
v_lshl_add_u32 v12, v12, 2, v13
v_mul_u32_u24 v12, 160, v12
v_and_b32 v13, 3, v0
v_lshl_add_u32 v12, v13, 3, v12
s_mul_i32 s4, s28, 10240
v_add_u32 v8, s4, v12
v_add_u32 v9, 61440, v8
s_lshl_b32 s3, s35, 11
s_add_u32 s36, s32, s3
s_add_u32 s37, s32, 20480
s_add_u32 s4, s36, 0
buffer_load_dwordx4 a[0:3], v7, s[12:15], s4 offen
s_add_u32 s4, s36, 40960
buffer_load_dwordx4 a[4:7], v7, s[12:15], s4 offen
s_add_u32 s4, s36, 1024
buffer_load_dwordx4 a[8:11], v7, s[12:15], s4 offen
s_add_u32 s4, s36, 41984
buffer_load_dwordx4 a[12:15], v7, s[12:15], s4 offen
s_add_u32 s36, s36, 2048
s_cmp_eq_u32 s36, s37
s_cselect_b32 s36, s32, s36
s_add_u32 s4, s36, 0
buffer_load_dwordx4 a[16:19], v7, s[12:15], s4 offen
s_add_u32 s4, s36, 40960
buffer_load_dwordx4 a[20:23], v7, s[12:15], s4 offen
s_add_u32 s4, s36, 1024
buffer_load_dwordx4 a[24:27], v7, s[12:15], s4 offen
s_add_u32 s4, s36, 41984
buffer_load_dwordx4 a[28:31], v7, s[12:15], s4 offen
s_add_u32 s36, s36, 2048
s_cmp_eq_u32 s36, s37
s_cselect_b32 s36, s32, s36
s_add_u32 s4, s36, 0
buffer_load_dwordx4 a[32:35], v7, s[12:15], s4 offen
s_add_u32 s4, s36, 40960
buffer_load_dwordx4 a[36:39], v7, s[12:15], s4 offen
s_add_u32 s4, s36, 1024
buffer_load_dwordx4 a[40:43], v7, s[12:15], s4 offen
s_add_u32 s4, s36, 41984
buffer_load_dwordx4 a[44:47], v7, s[12:15], s4 offen
s_add_u32 s36, s36, 2048
s_cmp_eq_u32 s36, s37
s_cselect_b32 s36, s32, s36
v_mov_b32 v64, 0
v_mov_b32 v65, 0
v_mov_b32 v66, 0
v_mov_b32 v67, 0
v_mov_b32 v68, 0
v_mov_b32 v69, 0
v_mov_b32 v70, 0
v_mov_b32 v71, 0
v_mov_b32 v72, 0
v_mov_b32 v73, 0
v_mov_b32 v74, 0
v_mov_b32 v75, 0
v_mov_b32 v76, 0
v_mov_b32 v77, 0
v_mov_b32 v78, 0
v_mov_b32 v79, 0
v_mov_b32 v80, 0
v_mov_b32 v81, 0
v_mov_b32 v82, 0
v_mov_b32 v83, 0
v_mov_b32 v84, 0
v_mov_b32 v85, 0
v_mov_b32 v86, 0
v_mov_b32 v87, 0
v_mov_b32 v88, 0
v_mov_b32 v89, 0
v_mov_b32 v90, 0
v_mov_b32 v91, 0
v_mov_b32 v92, 0
v_mov_b32 v93, 0
v_mov_b32 v94, 0
v_mov_b32 v95, 0
v_mov_b32 v96, 0
v_mov_b32 v97, 0
v_mov_b32 v98, 0
v_mov_b32 v99, 0
v_mov_b32 v100, 0
v_mov_b32 v101, 0
v_mov_b32 v102, 0
v_mov_b32 v103, 0
s_barrier
ds_read_b64_tr_b16 v[20:21], v8 offset:0
ds_read_b64_tr_b16 v[22:23], v8 offset:2560
ds_read_b64_tr_b16 v[24:25], v8 offset:32
ds_read_b64_tr_b16 v[26:27], v8 offset:2592
ds_read_b64_tr_b16 v[28:29], v8 offset:64
ds_read_b64_tr_b16 v[30:31], v8 offset:2624
ds_read_b64_tr_b16 v[32:33], v8 offset:96
ds_read_b64_tr_b16 v[34:35], v8 offset:2656
ds_read_b64_tr_b16 v[36:37], v8 offset:128
ds_read_b64_tr_b16 v[38:39], v8 offset:2688
s_waitcnt vmcnt(8) lgkmcnt(0)
ds_read_b64_tr_b16 v[40:41], v8 offset:5120
ds_read_b64_tr_b16 v[42:43], v8 offset:7680
v_mfma_f32_16x16x32_bf16 v[64:67], v[20:23], a[0:3], v[64:67]
ds_read_b64_tr_b16 v[44:45], v8 offset:5152
ds_read_b64_tr_b16 v[46:47], v8 offset:7712
v_mfma_f32_16x16x32_bf16 v[84:87], v[20:23], a[4:7], v[84:87]
ds_read_b64_tr_b16 v[48:49], v8 offset:5184
ds_read_b64_tr_b16 v[50:51], v8 offset:7744
v_mfma_f32_16x16x32_bf16 v[68:71], v[24:27], a[0:3], v[68:71]
ds_read_b64_tr_b16 v[52:53], v8 offset:5216
ds_read_b64_tr_b16 v[54:55], v8 offset:7776
v_mfma_f32_16x16x32_bf16 v[88:91], v[24:27], a[4:7], v[88:91]
ds_read_b64_tr_b16 v[56:57], v8 offset:5248
ds_read_b64_tr_b16 v[58:59], v8 offset:7808
v_mfma_f32_16x16x32_bf16 v[72:75], v[28:31], a[0:3], v[72:75]
v_mfma_f32_16x16x32_bf16 v[92:95], v[28:31], a[4:7], v[92:95]
s_add_u32 s4, s36, 0
buffer_load_dwordx4 a[48:51], v7, s[12:15], s4 offen
v_mfma_f32_16x16x32_bf16 v[76:79], v[32:35], a[0:3], v[76:79]
v_mfma_f32_16x16x32_bf16 v[96:99], v[32:35], a[4:7], v[96:99]
v_mfma_f32_16x16x32_bf16 v[80:83], v[36:39], a[0:3], v[80:83]
s_add_u32 s4, s36, 40960
buffer_load_dwordx4 a[52:55], v7, s[12:15], s4 offen
v_mfma_f32_16x16x32_bf16 v[100:103], v[36:39], a[4:7], v[100:103]
s_waitcnt lgkmcnt(0)
s_barrier
ds_read_b64_tr_b16 v[20:21], v8 offset:20480
ds_read_b64_tr_b16 v[22:23], v8 offset:23040
v_mfma_f32_16x16x32_bf16 v[64:67], v[40:43], a[8:11], v[64:67]
ds_read_b64_tr_b16 v[24:25], v8 offset:20512
ds_read_b64_tr_b16 v[26:27], v8 offset:23072
v_mfma_f32_16x16x32_bf16 v[84:87], v[40:43], a[12:15], v[84:87]
ds_read_b64_tr_b16 v[28:29], v8 offset:20544
ds_read_b64_tr_b16 v[30:31], v8 offset:23104
v_mfma_f32_16x16x32_bf16 v[68:71], v[44:47], a[8:11], v[68:71]
ds_read_b64_tr_b16 v[32:33], v8 offset:20576
ds_read_b64_tr_b16 v[34:35], v8 offset:23136
v_mfma_f32_16x16x32_bf16 v[88:91], v[44:47], a[12:15], v[88:91]
ds_read_b64_tr_b16 v[36:37], v8 offset:20608
ds_read_b64_tr_b16 v[38:39], v8 offset:23168
v_mfma_f32_16x16x32_bf16 v[72:75], v[48:51], a[8:11], v[72:75]
v_mfma_f32_16x16x32_bf16 v[92:95], v[48:51], a[12:15], v[92:95]
s_add_u32 s4, s36, 1024
buffer_load_dwordx4 a[56:59], v7, s[12:15], s4 offen
v_mfma_f32_16x16x32_bf16 v[76:79], v[52:55], a[8:11], v[76:79]
v_mfma_f32_16x16x32_bf16 v[96:99], v[52:55], a[12:15], v[96:99]
v_mfma_f32_16x16x32_bf16 v[80:83], v[56:59], a[8:11], v[80:83]
s_add_u32 s4, s36, 41984
buffer_load_dwordx4 a[60:63], v7, s[12:15], s4 offen
s_add_u32 s36, s36, 2048
s_cmp_eq_u32 s36, s37
s_cselect_b32 s36, s32, s36
v_mfma_f32_16x16x32_bf16 v[100:103], v[56:59], a[12:15], v[100:103]
s_waitcnt vmcnt(8) lgkmcnt(0)
ds_read_b64_tr_b16 v[40:41], v8 offset:25600
ds_read_b64_tr_b16 v[42:43], v8 offset:28160
v_mfma_f32_16x16x32_bf16 v[64:67], v[20:23], a[16:19], v[64:67]
ds_read_b64_tr_b16 v[44:45], v8 offset:25632
ds_read_b64_tr_b16 v[46:47], v8 offset:28192
v_mfma_f32_16x16x32_bf16 v[84:87], v[20:23], a[20:23], v[84:87]
ds_read_b64_tr_b16 v[48:49], v8 offset:25664
ds_read_b64_tr_b16 v[50:51], v8 offset:28224
v_mfma_f32_16x16x32_bf16 v[68:71], v[24:27], a[16:19], v[68:71]
ds_read_b64_tr_b16 v[52:53], v8 offset:25696
ds_read_b64_tr_b16 v[54:55], v8 offset:28256
v_mfma_f32_16x16x32_bf16 v[88:91], v[24:27], a[20:23], v[88:91]
ds_read_b64_tr_b16 v[56:57], v8 offset:25728
ds_read_b64_tr_b16 v[58:59], v8 offset:28288
v_mfma_f32_16x16x32_bf16 v[72:75], v[28:31], a[16:19], v[72:75]
v_mfma_f32_16x16x32_bf16 v[92:95], v[28:31], a[20:23], v[92:95]
s_add_u32 s4, s36, 0
buffer_load_dwordx4 a[64:67], v7, s[12:15], s4 offen
v_mfma_f32_16x16x32_bf16 v[76:79], v[32:35], a[16:19], v[76:79]
v_mfma_f32_16x16x32_bf16 v[96:99], v[32:35], a[20:23], v[96:99]
v_mfma_f32_16x16x32_bf16 v[80:83], v[36:39], a[16:19], v[80:83]
s_add_u32 s4, s36, 40960
buffer_load_dwordx4 a[68:71], v7, s[12:15], s4 offen
v_mfma_f32_16x16x32_bf16 v[100:103], v[36:39], a[20:23], v[100:103]
s_waitcnt lgkmcnt(0)
s_barrier
ds_read_b64_tr_b16 v[20:21], v8 offset:40960
ds_read_b64_tr_b16 v[22:23], v8 offset:43520
v_mfma_f32_16x16x32_bf16 v[64:67], v[40:43], a[24:27], v[64:67]
ds_read_b64_tr_b16 v[24:25], v8 offset:40992
ds_read_b64_tr_b16 v[26:27], v8 offset:43552
v_mfma_f32_16x16x32_bf16 v[84:87], v[40:43], a[28:31], v[84:87]
ds_read_b64_tr_b16 v[28:29], v8 offset:41024
ds_read_b64_tr_b16 v[30:31], v8 offset:43584
v_mfma_f32_16x16x32_bf16 v[68:71], v[44:47], a[24:27], v[68:71]
ds_read_b64_tr_b16 v[32:33], v8 offset:41056
ds_read_b64_tr_b16 v[34:35], v8 offset:43616
v_mfma_f32_16x16x32_bf16 v[88:91], v[44:47], a[28:31], v[88:91]
ds_read_b64_tr_b16 v[36:37], v8 offset:41088
ds_read_b64_tr_b16 v[38:39], v8 offset:43648
v_mfma_f32_16x16x32_bf16 v[72:75], v[48:51], a[24:27], v[72:75]
v_mfma_f32_16x16x32_bf16 v[92:95], v[48:51], a[28:31], v[92:95]
s_add_u32 s4, s36, 1024
buffer_load_dwordx4 a[72:75], v7, s[12:15], s4 offen
v_mfma_f32_16x16x32_bf16 v[76:79], v[52:55], a[24:27], v[76:79]
v_mfma_f32_16x16x32_bf16 v[96:99], v[52:55], a[28:31], v[96:99]
v_mfma_f32_16x16x32_bf16 v[80:83], v[56:59], a[24:27], v[80:83]
s_add_u32 s4, s36, 41984
buffer_load_dwordx4 a[76:79], v7, s[12:15], s4 offen
s_add_u32 s36, s36, 2048
s_cmp_eq_u32 s36, s37
s_cselect_b32 s36, s32, s36
v_mfma_f32_16x16x32_bf16 v[100:103], v[56:59], a[28:31], v[100:103]
s_waitcnt vmcnt(8) lgkmcnt(0)
ds_read_b64_tr_b16 v[40:41], v8 offset:46080
ds_read_b64_tr_b16 v[42:43], v8 offset:48640
v_mfma_f32_16x16x32_bf16 v[64:67], v[20:23], a[32:35], v[64:67]
ds_read_b64_tr_b16 v[44:45], v8 offset:46112
ds_read_b64_tr_b16 v[46:47], v8 offset:48672
v_mfma_f32_16x16x32_bf16 v[84:87], v[20:23], a[36:39], v[84:87]
ds_read_b64_tr_b16 v[48:49], v8 offset:46144
ds_read_b64_tr_b16 v[50:51], v8 offset:48704
v_mfma_f32_16x16x32_bf16 v[68:71], v[24:27], a[32:35], v[68:71]
ds_read_b64_tr_b16 v[52:53], v8 offset:46176
ds_read_b64_tr_b16 v[54:55], v8 offset:48736
v_mfma_f32_16x16x32_bf16 v[88:91], v[24:27], a[36:39], v[88:91]
ds_read_b64_tr_b16 v[56:57], v8 offset:46208
ds_read_b64_tr_b16 v[58:59], v8 offset:48768
v_mfma_f32_16x16x32_bf16 v[72:75], v[28:31], a[32:35], v[72:75]
v_mfma_f32_16x16x32_bf16 v[92:95], v[28:31], a[36:39], v[92:95]
s_add_u32 s4, s36, 0
buffer_load_dwordx4 a[80:83], v7, s[12:15], s4 offen
v_mfma_f32_16x16x32_bf16 v[76:79], v[32:35], a[32:35], v[76:79]
v_mfma_f32_16x16x32_bf16 v[96:99], v[32:35], a[36:39], v[96:99]
v_mfma_f32_16x16x32_bf16 v[80:83], v[36:39], a[32:35], v[80:83]
s_add_u32 s4, s36, 40960
buffer_load_dwordx4 a[84:87], v7, s[12:15], s4 offen
v_mfma_f32_16x16x32_bf16 v[100:103], v[36:39], a[36:39], v[100:103]
s_waitcnt lgkmcnt(0)
s_barrier
ds_read_b64_tr_b16 v[20:21], v9 offset:0
ds_read_b64_tr_b16 v[22:23], v9 offset:2560
v_mfma_f32_16x16x32_bf16 v[64:67], v[40:43], a[40:43], v[64:67]
ds_read_b64_tr_b16 v[24:25], v9 offset:32
ds_read_b64_tr_b16 v[26:27], v9 offset:2592
v_mfma_f32_16x16x32_bf16 v[84:87], v[40:43], a[44:47], v[84:87]
ds_read_b64_tr_b16 v[28:29], v9 offset:64
ds_read_b64_tr_b16 v[30:31], v9 offset:2624
v_mfma_f32_16x16x32_bf16 v[68:71], v[44:47], a[40:43], v[68:71]
ds_read_b64_tr_b16 v[32:33], v9 offset:96
ds_read_b64_tr_b16 v[34:35], v9 offset:2656
v_mfma_f32_16x16x32_bf16 v[88:91], v[44:47], a[44:47], v[88:91]
ds_read_b64_tr_b16 v[36:37], v9 offset:128
ds_read_b64_tr_b16 v[38:39], v9 offset:2688
v_mfma_f32_16x16x32_bf16 v[72:75], v[48:51], a[40:43], v[72:75]
v_mfma_f32_16x16x32_bf16 v[92:95], v[48:51], a[44:47], v[92:95]
s_add_u32 s4, s36, 1024
buffer_load_dwordx4 a[88:91], v7, s[12:15], s4 offen
v_mfma_f32_16x16x32_bf16 v[76:79], v[52:55], a[40:43], v[76:79]
v_mfma_f32_16x16x32_bf16 v[96:99], v[52:55], a[44:47], v[96:99]
v_mfma_f32_16x16x32_bf16 v[80:83], v[56:59], a[40:43], v[80:83]
s_add_u32 s4, s36, 41984
buffer_load_dwordx4 a[92:95], v7, s[12:15], s4 offen
s_add_u32 s36, s36, 2048
s_cmp_eq_u32 s36, s37
s_cselect_b32 s36, s32, s36
v_mfma_f32_16x16x32_bf16 v[100:103], v[56:59], a[44:47], v[100:103]
s_waitcnt vmcnt(8) lgkmcnt(0)
ds_read_b64_tr_b16 v[40:41], v9 offset:5120
ds_read_b64_tr_b16 v[42:43], v9 offset:7680
v_mfma_f32_16x16x32_bf16 v[64:67], v[20:23], a[48:51], v[64:67]
ds_read_b64_tr_b16 v[44:45], v9 offset:5152
ds_read_b64_tr_b16 v[46:47], v9 offset:7712
v_mfma_f32_16x16x32_bf16 v[84:87], v[20:23], a[52:55], v[84:87]
ds_read_b64_tr_b16 v[48:49], v9 offset:5184
ds_read_b64_tr_b16 v[50:51], v9 offset:7744
v_mfma_f32_16x16x32_bf16 v[68:71], v[24:27], a[48:51], v[68:71]
ds_read_b64_tr_b16 v[52:53], v9 offset:5216
ds_read_b64_tr_b16 v[54:55], v9 offset:7776
v_mfma_f32_16x16x32_bf16 v[88:91], v[24:27], a[52:55], v[88:91]
ds_read_b64_tr_b16 v[56:57], v9 offset:5248
ds_read_b64_tr_b16 v[58:59], v9 offset:7808
v_mfma_f32_16x16x32_bf16 v[72:75], v[28:31], a[48:51], v[72:75]
v_mfma_f32_16x16x32_bf16 v[92:95], v[28:31], a[52:55], v[92:95]
s_add_u32 s4, s36, 0
buffer_load_dwordx4 a[0:3], v7, s[12:15], s4 offen
v_mfma_f32_16x16x32_bf16 v[76:79], v[32:35], a[48:51], v[76:79]
v_mfma_f32_16x16x32_bf16 v[96:99], v[32:35], a[52:55], v[96:99]
v_mfma_f32_16x16x32_bf16 v[80:83], v[36:39], a[48:51], v[80:83]
s_add_u32 s4, s36, 40960
buffer_load_dwordx4 a[4:7], v7, s[12:15], s4 offen
v_mfma_f32_16x16x32_bf16 v[100:103], v[36:39], a[52:55], v[100:103]
s_waitcnt lgkmcnt(0)
s_barrier
ds_read_b64_tr_b16 v[20:21], v9 offset:20480
ds_read_b64_tr_b16 v[22:23], v9 offset:23040
v_mfma_f32_16x16x32_bf16 v[64:67], v[40:43], a[56:59], v[64:67]
ds_read_b64_tr_b16 v[24:25], v9 offset:20512
ds_read_b64_tr_b16 v[26:27], v9 offset:23072
v_mfma_f32_16x16x32_bf16 v[84:87], v[40:43], a[60:63], v[84:87]
ds_read_b64_tr_b16 v[28:29], v9 offset:20544
ds_read_b64_tr_b16 v[30:31], v9 offset:23104
v_mfma_f32_16x16x32_bf16 v[68:71], v[44:47], a[56:59], v[68:71]
ds_read_b64_tr_b16 v[32:33], v9 offset:20576
ds_read_b64_tr_b16 v[34:35], v9 offset:23136
v_mfma_f32_16x16x32_bf16 v[88:91], v[44:47], a[60:63], v[88:91]
ds_read_b64_tr_b16 v[36:37], v9 offset:20608
ds_read_b64_tr_b16 v[38:39], v9 offset:23168
v_mfma_f32_16x16x32_bf16 v[72:75], v[48:51], a[56:59], v[72:75]
v_mfma_f32_16x16x32_bf16 v[92:95], v[48:51], a[60:63], v[92:95]
s_add_u32 s4, s36, 1024
buffer_load_dwordx4 a[8:11], v7, s[12:15], s4 offen
v_mfma_f32_16x16x32_bf16 v[76:79], v[52:55], a[56:59], v[76:79]
v_mfma_f32_16x16x32_bf16 v[96:99], v[52:55], a[60:63], v[96:99]
v_mfma_f32_16x16x32_bf16 v[80:83], v[56:59], a[56:59], v[80:83]
s_add_u32 s4, s36, 41984
buffer_load_dwordx4 a[12:15], v7, s[12:15], s4 offen
s_add_u32 s36, s36, 2048
s_cmp_eq_u32 s36, s37
s_cselect_b32 s36, s32, s36
v_mfma_f32_16x16x32_bf16 v[100:103], v[56:59], a[60:63], v[100:103]
s_waitcnt vmcnt(8) lgkmcnt(0)
ds_read_b64_tr_b16 v[40:41], v9 offset:25600
ds_read_b64_tr_b16 v[42:43], v9 offset:28160
v_mfma_f32_16x16x32_bf16 v[64:67], v[20:23], a[64:67], v[64:67]
ds_read_b64_tr_b16 v[44:45], v9 offset:25632
ds_read_b64_tr_b16 v[46:47], v9 offset:28192
v_mfma_f32_16x16x32_bf16 v[84:87], v[20:23], a[68:71], v[84:87]
ds_read_b64_tr_b16 v[48:49], v9 offset:25664
ds_read_b64_tr_b16 v[50:51], v9 offset:28224
v_mfma_f32_16x16x32_bf16 v[68:71], v[24:27], a[64:67], v[68:71]
ds_read_b64_tr_b16 v[52:53], v9 offset:25696
ds_read_b64_tr_b16 v[54:55], v9 offset:28256
v_mfma_f32_16x16x32_bf16 v[88:91], v[24:27], a[68:71], v[88:91]
ds_read_b64_tr_b16 v[56:57], v9 offset:25728
ds_read_b64_tr_b16 v[58:59], v9 offset:28288
v_mfma_f32_16x16x32_bf16 v[72:75], v[28:31], a[64:67], v[72:75]
v_mfma_f32_16x16x32_bf16 v[92:95], v[28:31], a[68:71], v[92:95]
s_add_u32 s4, s36, 0
buffer_load_dwordx4 a[16:19], v7, s[12:15], s4 offen
v_mfma_f32_16x16x32_bf16 v[76:79], v[32:35], a[64:67], v[76:79]
v_mfma_f32_16x16x32_bf16 v[96:99], v[32:35], a[68:71], v[96:99]
v_mfma_f32_16x16x32_bf16 v[80:83], v[36:39], a[64:67], v[80:83]
s_add_u32 s4, s36, 40960
buffer_load_dwordx4 a[20:23], v7, s[12:15], s4 offen
v_mfma_f32_16x16x32_bf16 v[100:103], v[36:39], a[68:71], v[100:103]
s_waitcnt lgkmcnt(0)
s_barrier
ds_read_b64_tr_b16 v[20:21], v8 offset:0
ds_read_b64_tr_b16 v[22:23], v8 offset:2560
v_mfma_f32_16x16x32_bf16 v[64:67], v[40:43], a[72:75], v[64:67]
ds_read_b64_tr_b16 v[24:25], v8 offset:32
ds_read_b64_tr_b16 v[26:27], v8 offset:2592
v_mfma_f32_16x16x32_bf16 v[84:87], v[40:43], a[76:79], v[84:87]
ds_read_b64_tr_b16 v[28:29], v8 offset:64
ds_read_b64_tr_b16 v[30:31], v8 offset:2624
v_mfma_f32_16x16x32_bf16 v[68:71], v[44:47], a[72:75], v[68:71]
ds_read_b64_tr_b16 v[32:33], v8 offset:96
ds_read_b64_tr_b16 v[34:35], v8 offset:2656
v_mfma_f32_16x16x32_bf16 v[88:91], v[44:47], a[76:79], v[88:91]
ds_read_b64_tr_b16 v[36:37], v8 offset:128
ds_read_b64_tr_b16 v[38:39], v8 offset:2688
v_mfma_f32_16x16x32_bf16 v[72:75], v[48:51], a[72:75], v[72:75]
v_mfma_f32_16x16x32_bf16 v[92:95], v[48:51], a[76:79], v[92:95]
s_add_u32 s4, s36, 1024
buffer_load_dwordx4 a[24:27], v7, s[12:15], s4 offen
v_mfma_f32_16x16x32_bf16 v[76:79], v[52:55], a[72:75], v[76:79]
v_mfma_f32_16x16x32_bf16 v[96:99], v[52:55], a[76:79], v[96:99]
v_mfma_f32_16x16x32_bf16 v[80:83], v[56:59], a[72:75], v[80:83]
s_add_u32 s4, s36, 41984
buffer_load_dwordx4 a[28:31], v7, s[12:15], s4 offen
s_add_u32 s36, s36, 2048
s_cmp_eq_u32 s36, s37
s_cselect_b32 s36, s32, s36
v_mfma_f32_16x16x32_bf16 v[100:103], v[56:59], a[76:79], v[100:103]
s_waitcnt vmcnt(8) lgkmcnt(0)
ds_read_b64_tr_b16 v[40:41], v8 offset:5120
ds_read_b64_tr_b16 v[42:43], v8 offset:7680
v_mfma_f32_16x16x32_bf16 v[64:67], v[20:23], a[80:83], v[64:67]
ds_read_b64_tr_b16 v[44:45], v8 offset:5152
ds_read_b64_tr_b16 v[46:47], v8 offset:7712
v_mfma_f32_16x16x32_bf16 v[84:87], v[20:23], a[84:87], v[84:87]
ds_read_b64_tr_b16 v[48:49], v8 offset:5184
ds_read_b64_tr_b16 v[50:51], v8 offset:7744
v_mfma_f32_16x16x32_bf16 v[68:71], v[24:27], a[80:83], v[68:71]
ds_read_b64_tr_b16 v[52:53], v8 offset:5216
ds_read_b64_tr_b16 v[54:55], v8 offset:7776
v_mfma_f32_16x16x32_bf16 v[88:91], v[24:27], a[84:87], v[88:91]
ds_read_b64_tr_b16 v[56:57], v8 offset:5248
ds_read_b64_tr_b16 v[58:59], v8 offset:7808
v_mfma_f32_16x16x32_bf16 v[72:75], v[28:31], a[80:83], v[72:75]
v_mfma_f32_16x16x32_bf16 v[92:95], v[28:31], a[84:87], v[92:95]
s_add_u32 s4, s36, 0
buffer_load_dwordx4 a[32:35], v7, s[12:15], s4 offen
v_mfma_f32_16x16x32_bf16 v[76:79], v[32:35], a[80:83], v[76:79]
v_mfma_f32_16x16x32_bf16 v[96:99], v[32:35], a[84:87], v[96:99]
v_mfma_f32_16x16x32_bf16 v[80:83], v[36:39], a[80:83], v[80:83]
s_add_u32 s4, s36, 40960
buffer_load_dwordx4 a[36:39], v7, s[12:15], s4 offen
v_mfma_f32_16x16x32_bf16 v[100:103], v[36:39], a[84:87], v[100:103]
s_waitcnt lgkmcnt(0)
s_barrier
ds_read_b64_tr_b16 v[20:21], v8 offset:20480
ds_read_b64_tr_b16 v[22:23], v8 offset:23040
v_mfma_f32_16x16x32_bf16 v[64:67], v[40:43], a[88:91], v[64:67]
ds_read_b64_tr_b16 v[24:25], v8 offset:20512
ds_read_b64_tr_b16 v[26:27], v8 offset:23072
v_mfma_f32_16x16x32_bf16 v[84:87], v[40:43], a[92:95], v[84:87]
ds_read_b64_tr_b16 v[28:29], v8 offset:20544
ds_read_b64_tr_b16 v[30:31], v8 offset:23104
v_mfma_f32_16x16x32_bf16 v[68:71], v[44:47], a[88:91], v[68:71]
ds_read_b64_tr_b16 v[32:33], v8 offset:20576
ds_read_b64_tr_b16 v[34:35], v8 offset:23136
v_mfma_f32_16x16x32_bf16 v[88:91], v[44:47], a[92:95], v[88:91]
ds_read_b64_tr_b16 v[36:37], v8 offset:20608
ds_read_b64_tr_b16 v[38:39], v8 offset:23168
v_mfma_f32_16x16x32_bf16 v[72:75], v[48:51], a[88:91], v[72:75]
v_mfma_f32_16x16x32_bf16 v[92:95], v[48:51], a[92:95], v[92:95]
s_add_u32 s4, s36, 1024
buffer_load_dwordx4 a[40:43], v7, s[12:15], s4 offen
v_mfma_f32_16x16x32_bf16 v[76:79], v[52:55], a[88:91], v[76:79]
v_mfma_f32_16x16x32_bf16 v[96:99], v[52:55], a[92:95], v[96:99]
v_mfma_f32_16x16x32_bf16 v[80:83], v[56:59], a[88:91], v[80:83]
s_add_u32 s4, s36, 41984
buffer_load_dwordx4 a[44:47], v7, s[12:15], s4 offen
s_add_u32 s36, s36, 2048
s_cmp_eq_u32 s36, s37
s_cselect_b32 s36, s32, s36
v_mfma_f32_16x16x32_bf16 v[100:103], v[56:59], a[92:95], v[100:103]
s_waitcnt vmcnt(8) lgkmcnt(0)
ds_read_b64_tr_b16 v[40:41], v8 offset:25600
ds_read_b64_tr_b16 v[42:43], v8 offset:28160
v_mfma_f32_16x16x32_bf16 v[64:67], v[20:23], a[0:3], v[64:67]
ds_read_b64_tr_b16 v[44:45], v8 offset:25632
ds_read_b64_tr_b16 v[46:47], v8 offset:28192
v_mfma_f32_16x16x32_bf16 v[84:87], v[20:23], a[4:7], v[84:87]
ds_read_b64_tr_b16 v[48:49], v8 offset:25664
ds_read_b64_tr_b16 v[50:51], v8 offset:28224
v_mfma_f32_16x16x32_bf16 v[68:71], v[24:27], a[0:3], v[68:71]
ds_read_b64_tr_b16 v[52:53], v8 offset:25696
ds_read_b64_tr_b16 v[54:55], v8 offset:28256
v_mfma_f32_16x16x32_bf16 v[88:91], v[24:27], a[4:7], v[88:91]
ds_read_b64_tr_b16 v[56:57], v8 offset:25728
ds_read_b64_tr_b16 v[58:59], v8 offset:28288
v_mfma_f32_16x16x32_bf16 v[72:75], v[28:31], a[0:3], v[72:75]
v_mfma_f32_16x16x32_bf16 v[92:95], v[28:31], a[4:7], v[92:95]
s_add_u32 s4, s36, 0
buffer_load_dwordx4 a[48:51], v7, s[12:15], s4 offen
v_mfma_f32_16x16x32_bf16 v[76:79], v[32:35], a[0:3], v[76:79]
v_mfma_f32_16x16x32_bf16 v[96:99], v[32:35], a[4:7], v[96:99]
v_mfma_f32_16x16x32_bf16 v[80:83], v[36:39], a[0:3], v[80:83]
s_add_u32 s4, s36, 40960
buffer_load_dwordx4 a[52:55], v7, s[12:15], s4 offen
v_mfma_f32_16x16x32_bf16 v[100:103], v[36:39], a[4:7], v[100:103]
s_waitcnt lgkmcnt(0)
s_barrier
ds_read_b64_tr_b16 v[20:21], v8 offset:40960
ds_read_b64_tr_b16 v[22:23], v8 offset:43520
v_mfma_f32_16x16x32_bf16 v[64:67], v[40:43], a[8:11], v[64:67]
ds_read_b64_tr_b16 v[24:25], v8 offset:40992
ds_read_b64_tr_b16 v[26:27], v8 offset:43552
v_mfma_f32_16x16x32_bf16 v[84:87], v[40:43], a[12:15], v[84:87]
ds_read_b64_tr_b16 v[28:29], v8 offset:41024
ds_read_b64_tr_b16 v[30:31], v8 offset:43584
v_mfma_f32_16x16x32_bf16 v[68:71], v[44:47], a[8:11], v[68:71]
ds_read_b64_tr_b16 v[32:33], v8 offset:41056
ds_read_b64_tr_b16 v[34:35], v8 offset:43616
v_mfma_f32_16x16x32_bf16 v[88:91], v[44:47], a[12:15], v[88:91]
ds_read_b64_tr_b16 v[36:37], v8 offset:41088
ds_read_b64_tr_b16 v[38:39], v8 offset:43648
v_mfma_f32_16x16x32_bf16 v[72:75], v[48:51], a[8:11], v[72:75]
v_mfma_f32_16x16x32_bf16 v[92:95], v[48:51], a[12:15], v[92:95]
s_add_u32 s4, s36, 1024
buffer_load_dwordx4 a[56:59], v7, s[12:15], s4 offen
v_mfma_f32_16x16x32_bf16 v[76:79], v[52:55], a[8:11], v[76:79]
v_mfma_f32_16x16x32_bf16 v[96:99], v[52:55], a[12:15], v[96:99]
v_mfma_f32_16x16x32_bf16 v[80:83], v[56:59], a[8:11], v[80:83]
s_add_u32 s4, s36, 41984
buffer_load_dwordx4 a[60:63], v7, s[12:15], s4 offen
s_add_u32 s36, s36, 2048
s_cmp_eq_u32 s36, s37
s_cselect_b32 s36, s32, s36
v_mfma_f32_16x16x32_bf16 v[100:103], v[56:59], a[12:15], v[100:103]
s_waitcnt vmcnt(8) lgkmcnt(0)
ds_read_b64_tr_b16 v[40:41], v8 offset:46080
ds_read_b64_tr_b16 v[42:43], v8 offset:48640
v_mfma_f32_16x16x32_bf16 v[64:67], v[20:23], a[16:19], v[64:67]
ds_read_b64_tr_b16 v[44:45], v8 offset:46112
ds_read_b64_tr_b16 v[46:47], v8 offset:48672
v_mfma_f32_16x16x32_bf16 v[84:87], v[20:23], a[20:23], v[84:87]
ds_read_b64_tr_b16 v[48:49], v8 offset:46144
ds_read_b64_tr_b16 v[50:51], v8 offset:48704
v_mfma_f32_16x16x32_bf16 v[68:71], v[24:27], a[16:19], v[68:71]
ds_read_b64_tr_b16 v[52:53], v8 offset:46176
ds_read_b64_tr_b16 v[54:55], v8 offset:48736
v_mfma_f32_16x16x32_bf16 v[88:91], v[24:27], a[20:23], v[88:91]
ds_read_b64_tr_b16 v[56:57], v8 offset:46208
ds_read_b64_tr_b16 v[58:59], v8 offset:48768
v_mfma_f32_16x16x32_bf16 v[72:75], v[28:31], a[16:19], v[72:75]
v_mfma_f32_16x16x32_bf16 v[92:95], v[28:31], a[20:23], v[92:95]
v_mfma_f32_16x16x32_bf16 v[76:79], v[32:35], a[16:19], v[76:79]
v_mfma_f32_16x16x32_bf16 v[96:99], v[32:35], a[20:23], v[96:99]
v_mfma_f32_16x16x32_bf16 v[80:83], v[36:39], a[16:19], v[80:83]
v_mfma_f32_16x16x32_bf16 v[100:103], v[36:39], a[20:23], v[100:103]
s_waitcnt lgkmcnt(0)
s_barrier
ds_read_b64_tr_b16 v[20:21], v9 offset:0
ds_read_b64_tr_b16 v[22:23], v9 offset:2560
v_mfma_f32_16x16x32_bf16 v[64:67], v[40:43], a[24:27], v[64:67]
ds_read_b64_tr_b16 v[24:25], v9 offset:32
ds_read_b64_tr_b16 v[26:27], v9 offset:2592
v_mfma_f32_16x16x32_bf16 v[84:87], v[40:43], a[28:31], v[84:87]
ds_read_b64_tr_b16 v[28:29], v9 offset:64
ds_read_b64_tr_b16 v[30:31], v9 offset:2624
v_mfma_f32_16x16x32_bf16 v[68:71], v[44:47], a[24:27], v[68:71]
ds_read_b64_tr_b16 v[32:33], v9 offset:96
ds_read_b64_tr_b16 v[34:35], v9 offset:2656
v_mfma_f32_16x16x32_bf16 v[88:91], v[44:47], a[28:31], v[88:91]
ds_read_b64_tr_b16 v[36:37], v9 offset:128
ds_read_b64_tr_b16 v[38:39], v9 offset:2688
v_mfma_f32_16x16x32_bf16 v[72:75], v[48:51], a[24:27], v[72:75]
v_mfma_f32_16x16x32_bf16 v[92:95], v[48:51], a[28:31], v[92:95]
v_mfma_f32_16x16x32_bf16 v[76:79], v[52:55], a[24:27], v[76:79]
v_mfma_f32_16x16x32_bf16 v[96:99], v[52:55], a[28:31], v[96:99]
v_mfma_f32_16x16x32_bf16 v[80:83], v[56:59], a[24:27], v[80:83]
v_mfma_f32_16x16x32_bf16 v[100:103], v[56:59], a[28:31], v[100:103]
s_waitcnt vmcnt(4) lgkmcnt(0)
ds_read_b64_tr_b16 v[40:41], v9 offset:5120
ds_read_b64_tr_b16 v[42:43], v9 offset:7680
v_mfma_f32_16x16x32_bf16 v[64:67], v[20:23], a[32:35], v[64:67]
ds_read_b64_tr_b16 v[44:45], v9 offset:5152
ds_read_b64_tr_b16 v[46:47], v9 offset:7712
v_mfma_f32_16x16x32_bf16 v[84:87], v[20:23], a[36:39], v[84:87]
ds_read_b64_tr_b16 v[48:49], v9 offset:5184
ds_read_b64_tr_b16 v[50:51], v9 offset:7744
v_mfma_f32_16x16x32_bf16 v[68:71], v[24:27], a[32:35], v[68:71]
ds_read_b64_tr_b16 v[52:53], v9 offset:5216
ds_read_b64_tr_b16 v[54:55], v9 offset:7776
v_mfma_f32_16x16x32_bf16 v[88:91], v[24:27], a[36:39], v[88:91]
ds_read_b64_tr_b16 v[56:57], v9 offset:5248
ds_read_b64_tr_b16 v[58:59], v9 offset:7808
v_mfma_f32_16x16x32_bf16 v[72:75], v[28:31], a[32:35], v[72:75]
v_mfma_f32_16x16x32_bf16 v[92:95], v[28:31], a[36:39], v[92:95]
v_mfma_f32_16x16x32_bf16 v[76:79], v[32:35], a[32:35], v[76:79]
v_mfma_f32_16x16x32_bf16 v[96:99], v[32:35], a[36:39], v[96:99]
v_mfma_f32_16x16x32_bf16 v[80:83], v[36:39], a[32:35], v[80:83]
v_mfma_f32_16x16x32_bf16 v[100:103], v[36:39], a[36:39], v[100:103]
s_waitcnt lgkmcnt(0)
s_barrier
ds_read_b64_tr_b16 v[20:21], v9 offset:20480
ds_read_b64_tr_b16 v[22:23], v9 offset:23040
v_mfma_f32_16x16x32_bf16 v[64:67], v[40:43], a[40:43], v[64:67]
ds_read_b64_tr_b16 v[24:25], v9 offset:20512
ds_read_b64_tr_b16 v[26:27], v9 offset:23072
v_mfma_f32_16x16x32_bf16 v[84:87], v[40:43], a[44:47], v[84:87]
ds_read_b64_tr_b16 v[28:29], v9 offset:20544
ds_read_b64_tr_b16 v[30:31], v9 offset:23104
v_mfma_f32_16x16x32_bf16 v[68:71], v[44:47], a[40:43], v[68:71]
ds_read_b64_tr_b16 v[32:33], v9 offset:20576
ds_read_b64_tr_b16 v[34:35], v9 offset:23136
v_mfma_f32_16x16x32_bf16 v[88:91], v[44:47], a[44:47], v[88:91]
ds_read_b64_tr_b16 v[36:37], v9 offset:20608
ds_read_b64_tr_b16 v[38:39], v9 offset:23168
v_mfma_f32_16x16x32_bf16 v[72:75], v[48:51], a[40:43], v[72:75]
v_mfma_f32_16x16x32_bf16 v[92:95], v[48:51], a[44:47], v[92:95]
v_mfma_f32_16x16x32_bf16 v[76:79], v[52:55], a[40:43], v[76:79]
v_mfma_f32_16x16x32_bf16 v[96:99], v[52:55], a[44:47], v[96:99]
v_mfma_f32_16x16x32_bf16 v[80:83], v[56:59], a[40:43], v[80:83]
v_mfma_f32_16x16x32_bf16 v[100:103], v[56:59], a[44:47], v[100:103]
s_waitcnt vmcnt(0) lgkmcnt(0)
ds_read_b64_tr_b16 v[40:41], v9 offset:25600
ds_read_b64_tr_b16 v[42:43], v9 offset:28160
v_mfma_f32_16x16x32_bf16 v[64:67], v[20:23], a[48:51], v[64:67]
ds_read_b64_tr_b16 v[44:45], v9 offset:25632
ds_read_b64_tr_b16 v[46:47], v9 offset:28192
v_mfma_f32_16x16x32_bf16 v[84:87], v[20:23], a[52:55], v[84:87]
ds_read_b64_tr_b16 v[48:49], v9 offset:25664
ds_read_b64_tr_b16 v[50:51], v9 offset:28224
v_mfma_f32_16x16x32_bf16 v[68:71], v[24:27], a[48:51], v[68:71]
ds_read_b64_tr_b16 v[52:53], v9 offset:25696
ds_read_b64_tr_b16 v[54:55], v9 offset:28256
v_mfma_f32_16x16x32_bf16 v[88:91], v[24:27], a[52:55], v[88:91]
ds_read_b64_tr_b16 v[56:57], v9 offset:25728
ds_read_b64_tr_b16 v[58:59], v9 offset:28288
v_mfma_f32_16x16x32_bf16 v[72:75], v[28:31], a[48:51], v[72:75]
v_mfma_f32_16x16x32_bf16 v[92:95], v[28:31], a[52:55], v[92:95]
v_mfma_f32_16x16x32_bf16 v[76:79], v[32:35], a[48:51], v[76:79]
v_mfma_f32_16x16x32_bf16 v[96:99], v[32:35], a[52:55], v[96:99]
v_mfma_f32_16x16x32_bf16 v[80:83], v[36:39], a[48:51], v[80:83]
v_mfma_f32_16x16x32_bf16 v[100:103], v[36:39], a[52:55], v[100:103]
s_waitcnt lgkmcnt(0)
v_mfma_f32_16x16x32_bf16 v[64:67], v[40:43], a[56:59], v[64:67]
v_mfma_f32_16x16x32_bf16 v[84:87], v[40:43], a[60:63], v[84:87]
v_mfma_f32_16x16x32_bf16 v[68:71], v[44:47], a[56:59], v[68:71]
v_mfma_f32_16x16x32_bf16 v[88:91], v[44:47], a[60:63], v[88:91]
v_mfma_f32_16x16x32_bf16 v[72:75], v[48:51], a[56:59], v[72:75]
v_mfma_f32_16x16x32_bf16 v[92:95], v[48:51], a[60:63], v[92:95]
v_mfma_f32_16x16x32_bf16 v[76:79], v[52:55], a[56:59], v[76:79]
v_mfma_f32_16x16x32_bf16 v[96:99], v[52:55], a[60:63], v[96:99]
v_mfma_f32_16x16x32_bf16 v[80:83], v[56:59], a[56:59], v[80:83]
v_mfma_f32_16x16x32_bf16 v[100:103], v[56:59], a[60:63], v[100:103]
s_nop 7
s_nop 7
s_barrier
v_lshlrev_b32 v12, 4, v0
v_add_u32 v13, s33, v12
s_xor_b32 s4, s27, 2
s_mul_i32 s4, s4, 5120
v_add_u32 v14, s4, v12
s_cmp_eq_u32 s28, 0
s_cbranch_scc1 K3_KH0
ds_write_b128 v13, v[64:67] offset:0
ds_write_b128 v13, v[68:71] offset:1024
ds_write_b128 v13, v[72:75] offset:2048
ds_write_b128 v13, v[76:79] offset:3072
ds_write_b128 v13, v[80:83] offset:4096
s_waitcnt lgkmcnt(0)
s_barrier
ds_read_b128 v[20:23], v14 offset:0
ds_read_b128 v[24:27], v14 offset:1024
ds_read_b128 v[28:31], v14 offset:2048
ds_read_b128 v[32:35], v14 offset:3072
ds_read_b128 v[36:39], v14 offset:4096
s_add_u32 s4, s31, 1
s_lshl_b32 s4, s4, 4
v_and_b32 v15, 15, v0
v_add_u32 v15, s4, v15
v_mul_u32_u24 v15, 1280, v15
v_lshrrev_b32 v16, 4, v0
v_lshl_add_u32 v15, v16, 3, v15
v_add_u32 v15, s30, v15
s_waitcnt lgkmcnt(0)
v_add_f32 v84, v84, v20
v_add_f32 v85, v85, v21
v_add_f32 v86, v86, v22
v_add_f32 v87, v87, v23
v_cvt_pk_bf16_f32 v40, v84, v85
v_cvt_pk_bf16_f32 v41, v86, v87
buffer_store_dwordx2 v[40:41], v15, s[16:19], 0 offen offset:0
v_add_f32 v88, v88, v24
v_add_f32 v89, v89, v25
v_add_f32 v90, v90, v26
v_add_f32 v91, v91, v27
v_cvt_pk_bf16_f32 v42, v88, v89
v_cvt_pk_bf16_f32 v43, v90, v91
buffer_store_dwordx2 v[42:43], v15, s[16:19], 0 offen offset:32
v_add_f32 v92, v92, v28
v_add_f32 v93, v93, v29
v_add_f32 v94, v94, v30
v_add_f32 v95, v95, v31
v_cvt_pk_bf16_f32 v44, v92, v93
v_cvt_pk_bf16_f32 v45, v94, v95
buffer_store_dwordx2 v[44:45], v15, s[16:19], 0 offen offset:64
v_add_f32 v96, v96, v32
v_add_f32 v97, v97, v33
v_add_f32 v98, v98, v34
v_add_f32 v99, v99, v35
v_cvt_pk_bf16_f32 v46, v96, v97
v_cvt_pk_bf16_f32 v47, v98, v99
buffer_store_dwordx2 v[46:47], v15, s[16:19], 0 offen offset:96
v_add_f32 v100, v100, v36
v_add_f32 v101, v101, v37
v_add_f32 v102, v102, v38
v_add_f32 v103, v103, v39
v_cvt_pk_bf16_f32 v48, v100, v101
v_cvt_pk_bf16_f32 v49, v102, v103
buffer_store_dwordx2 v[48:49], v15, s[16:19], 0 offen offset:128
s_endpgm
K3_KH0:
ds_write_b128 v13, v[84:87] offset:0
ds_write_b128 v13, v[88:91] offset:1024
ds_write_b128 v13, v[92:95] offset:2048
ds_write_b128 v13, v[96:99] offset:3072
ds_write_b128 v13, v[100:103] offset:4096
s_waitcnt lgkmcnt(0)
s_barrier
ds_read_b128 v[20:23], v14 offset:0
ds_read_b128 v[24:27], v14 offset:1024
ds_read_b128 v[28:31], v14 offset:2048
ds_read_b128 v[32:35], v14 offset:3072
ds_read_b128 v[36:39], v14 offset:4096
s_add_u32 s4, s31, 0
s_lshl_b32 s4, s4, 4
v_and_b32 v15, 15, v0
v_add_u32 v15, s4, v15
v_mul_u32_u24 v15, 1280, v15
v_lshrrev_b32 v16, 4, v0
v_lshl_add_u32 v15, v16, 3, v15
v_add_u32 v15, s30, v15
s_waitcnt lgkmcnt(0)
v_add_f32 v64, v64, v20
v_add_f32 v65, v65, v21
v_add_f32 v66, v66, v22
v_add_f32 v67, v67, v23
v_cvt_pk_bf16_f32 v40, v64, v65
v_cvt_pk_bf16_f32 v41, v66, v67
buffer_store_dwordx2 v[40:41], v15, s[16:19], 0 offen offset:0
v_add_f32 v68, v68, v24
v_add_f32 v69, v69, v25
v_add_f32 v70, v70, v26
v_add_f32 v71, v71, v27
v_cvt_pk_bf16_f32 v42, v68, v69
v_cvt_pk_bf16_f32 v43, v70, v71
buffer_store_dwordx2 v[42:43], v15, s[16:19], 0 offen offset:32
v_add_f32 v72, v72, v28
v_add_f32 v73, v73, v29
v_add_f32 v74, v74, v30
v_add_f32 v75, v75, v31
v_cvt_pk_bf16_f32 v44, v72, v73
v_cvt_pk_bf16_f32 v45, v74, v75
buffer_store_dwordx2 v[44:45], v15, s[16:19], 0 offen offset:64
v_add_f32 v76, v76, v32
v_add_f32 v77, v77, v33
v_add_f32 v78, v78, v34
v_add_f32 v79, v79, v35
v_cvt_pk_bf16_f32 v46, v76, v77
v_cvt_pk_bf16_f32 v47, v78, v79
buffer_store_dwordx2 v[46:47], v15, s[16:19], 0 offen offset:96
v_add_f32 v80, v80, v36
v_add_f32 v81, v81, v37
v_add_f32 v82, v82, v38
v_add_f32 v83, v83, v39
v_cvt_pk_bf16_f32 v48, v80, v81
v_cvt_pk_bf16_f32 v49, v82, v83
buffer_store_dwordx2 v[48:49], v15, s[16:19], 0 offen offset:128
s_endpgm
K3_PROD:
s_mov_b32 s12, s22
s_and_b32 s13, s23, 0xffff
s_mov_b32 s14, 0x10000000
s_mov_b32 s15, 0x20000
s_mul_i32 s33, s27, 5120
s_setprio 2
s_mul_i32 s3, s28, 819200
s_mul_i32 s4, s26, 10240
s_add_u32 s3, s3, s4
s_mul_i32 s4, s29, 5120
s_add_u32 s3, s3, s4
s_add_u32 s38, s3, 20971520
s_add_u32 s39, s38, 819200
s_mul_i32 s4, s35, 81920
s_add_u32 s36, s38, s4
v_lshlrev_b32 v2, 4, v0
s_add_u32 m0, s33, 0
s_add_u32 s4, s36, 0
buffer_load_dwordx4 v2, s[12:15], s4 offen lds
s_add_u32 m0, s33, 1024
s_add_u32 s4, s36, 1024
buffer_load_dwordx4 v2, s[12:15], s4 offen lds
s_add_u32 m0, s33, 2048
s_add_u32 s4, s36, 2048
buffer_load_dwordx4 v2, s[12:15], s4 offen lds
s_add_u32 m0, s33, 3072
s_add_u32 s4, s36, 3072
buffer_load_dwordx4 v2, s[12:15], s4 offen lds
s_add_u32 m0, s33, 4096
s_add_u32 s4, s36, 4096
buffer_load_dwordx4 v2, s[12:15], s4 offen lds
s_add_u32 s36, s36, 81920
s_cmp_eq_u32 s36, s39
s_cselect_b32 s36, s38, s36
s_add_u32 m0, s33, 20480
s_add_u32 s4, s36, 0
buffer_load_dwordx4 v2, s[12:15], s4 offen lds
s_add_u32 m0, s33, 21504
s_add_u32 s4, s36, 1024
buffer_load_dwordx4 v2, s[12:15], s4 offen lds
s_add_u32 m0, s33, 22528
s_add_u32 s4, s36, 2048
buffer_load_dwordx4 v2, s[12:15], s4 offen lds
s_add_u32 m0, s33, 23552
s_add_u32 s4, s36, 3072
buffer_load_dwordx4 v2, s[12:15], s4 offen lds
s_add_u32 m0, s33, 24576
s_add_u32 s4, s36, 4096
buffer_load_dwordx4 v2, s[12:15], s4 offen lds
s_add_u32 s36, s36, 81920
s_cmp_eq_u32 s36, s39
s_cselect_b32 s36, s38, s36
s_add_u32 m0, s33, 40960
s_add_u32 s4, s36, 0
buffer_load_dwordx4 v2, s[12:15], s4 offen lds
s_add_u32 m0, s33, 41984
s_add_u32 s4, s36, 1024
buffer_load_dwordx4 v2, s[12:15], s4 offen lds
s_add_u32 m0, s33, 43008
s_add_u32 s4, s36, 2048
buffer_load_dwordx4 v2, s[12:15], s4 offen lds
s_add_u32 m0, s33, 44032
s_add_u32 s4, s36, 3072
buffer_load_dwordx4 v2, s[12:15], s4 offen lds
s_add_u32 m0, s33, 45056
s_add_u32 s4, s36, 4096
buffer_load_dwordx4 v2, s[12:15], s4 offen lds
s_add_u32 s36, s36, 81920
s_cmp_eq_u32 s36, s39
s_cselect_b32 s36, s38, s36
s_waitcnt vmcnt(10)
s_barrier
s_add_u32 m0, s33, 61440
s_add_u32 s4, s36, 0
buffer_load_dwordx4 v2, s[12:15], s4 offen lds
s_add_u32 m0, s33, 62464
s_add_u32 s4, s36, 1024
buffer_load_dwordx4 v2, s[12:15], s4 offen lds
s_add_u32 m0, s33, 63488
s_add_u32 s4, s36, 2048
buffer_load_dwordx4 v2, s[12:15], s4 offen lds
s_add_u32 m0, s33, 64512
s_add_u32 s4, s36, 3072
buffer_load_dwordx4 v2, s[12:15], s4 offen lds
s_add_u32 m0, s33, 65536
s_add_u32 s4, s36, 4096
buffer_load_dwordx4 v2, s[12:15], s4 offen lds
s_add_u32 s36, s36, 81920
s_cmp_eq_u32 s36, s39
s_cselect_b32 s36, s38, s36
s_add_u32 m0, s33, 81920
s_add_u32 s4, s36, 0
buffer_load_dwordx4 v2, s[12:15], s4 offen lds
s_add_u32 m0, s33, 82944
s_add_u32 s4, s36, 1024
buffer_load_dwordx4 v2, s[12:15], s4 offen lds
s_add_u32 m0, s33, 83968
s_add_u32 s4, s36, 2048
buffer_load_dwordx4 v2, s[12:15], s4 offen lds
s_add_u32 m0, s33, 84992
s_add_u32 s4, s36, 3072
buffer_load_dwordx4 v2, s[12:15], s4 offen lds
s_add_u32 m0, s33, 86016
s_add_u32 s4, s36, 4096
buffer_load_dwordx4 v2, s[12:15], s4 offen lds
s_add_u32 s36, s36, 81920
s_cmp_eq_u32 s36, s39
s_cselect_b32 s36, s38, s36
s_waitcnt vmcnt(15)
s_barrier
s_add_u32 m0, s33, 0
s_add_u32 s4, s36, 0
buffer_load_dwordx4 v2, s[12:15], s4 offen lds
s_add_u32 m0, s33, 1024
s_add_u32 s4, s36, 1024
buffer_load_dwordx4 v2, s[12:15], s4 offen lds
s_add_u32 m0, s33, 2048
s_add_u32 s4, s36, 2048
buffer_load_dwordx4 v2, s[12:15], s4 offen lds
s_add_u32 m0, s33, 3072
s_add_u32 s4, s36, 3072
buffer_load_dwordx4 v2, s[12:15], s4 offen lds
s_add_u32 m0, s33, 4096
s_add_u32 s4, s36, 4096
buffer_load_dwordx4 v2, s[12:15], s4 offen lds
s_add_u32 s36, s36, 81920
s_cmp_eq_u32 s36, s39
s_cselect_b32 s36, s38, s36
s_waitcnt vmcnt(15)
s_barrier
s_add_u32 m0, s33, 20480
s_add_u32 s4, s36, 0
buffer_load_dwordx4 v2, s[12:15], s4 offen lds
s_add_u32 m0, s33, 21504
s_add_u32 s4, s36, 1024
buffer_load_dwordx4 v2, s[12:15], s4 offen lds
s_add_u32 m0, s33, 22528
s_add_u32 s4, s36, 2048
buffer_load_dwordx4 v2, s[12:15], s4 offen lds
s_add_u32 m0, s33, 23552
s_add_u32 s4, s36, 3072
buffer_load_dwordx4 v2, s[12:15], s4 offen lds
s_add_u32 m0, s33, 24576
s_add_u32 s4, s36, 4096
buffer_load_dwordx4 v2, s[12:15], s4 offen lds
s_add_u32 s36, s36, 81920
s_cmp_eq_u32 s36, s39
s_cselect_b32 s36, s38, s36
s_waitcnt vmcnt(15)
s_barrier
s_add_u32 m0, s33, 40960
s_add_u32 s4, s36, 0
buffer_load_dwordx4 v2, s[12:15], s4 offen lds
s_add_u32 m0, s33, 41984
s_add_u32 s4, s36, 1024
buffer_load_dwordx4 v2, s[12:15], s4 offen lds
s_add_u32 m0, s33, 43008
s_add_u32 s4, s36, 2048
buffer_load_dwordx4 v2, s[12:15], s4 offen lds
s_add_u32 m0, s33, 44032
s_add_u32 s4, s36, 3072
buffer_load_dwordx4 v2, s[12:15], s4 offen lds
s_add_u32 m0, s33, 45056
s_add_u32 s4, s36, 4096
buffer_load_dwordx4 v2, s[12:15], s4 offen lds
s_add_u32 s36, s36, 81920
s_cmp_eq_u32 s36, s39
s_cselect_b32 s36, s38, s36
s_waitcnt vmcnt(15)
s_barrier
s_add_u32 m0, s33, 61440
s_add_u32 s4, s36, 0
buffer_load_dwordx4 v2, s[12:15], s4 offen lds
s_add_u32 m0, s33, 62464
s_add_u32 s4, s36, 1024
buffer_load_dwordx4 v2, s[12:15], s4 offen lds
s_add_u32 m0, s33, 63488
s_add_u32 s4, s36, 2048
buffer_load_dwordx4 v2, s[12:15], s4 offen lds
s_add_u32 m0, s33, 64512
s_add_u32 s4, s36, 3072
buffer_load_dwordx4 v2, s[12:15], s4 offen lds
s_add_u32 m0, s33, 65536
s_add_u32 s4, s36, 4096
buffer_load_dwordx4 v2, s[12:15], s4 offen lds
s_add_u32 s36, s36, 81920
s_cmp_eq_u32 s36, s39
s_cselect_b32 s36, s38, s36
s_waitcnt vmcnt(15)
s_barrier
s_add_u32 m0, s33, 81920
s_add_u32 s4, s36, 0
buffer_load_dwordx4 v2, s[12:15], s4 offen lds
s_add_u32 m0, s33, 82944
s_add_u32 s4, s36, 1024
buffer_load_dwordx4 v2, s[12:15], s4 offen lds
s_add_u32 m0, s33, 83968
s_add_u32 s4, s36, 2048
buffer_load_dwordx4 v2, s[12:15], s4 offen lds
s_add_u32 m0, s33, 84992
s_add_u32 s4, s36, 3072
buffer_load_dwordx4 v2, s[12:15], s4 offen lds
s_add_u32 m0, s33, 86016
s_add_u32 s4, s36, 4096
buffer_load_dwordx4 v2, s[12:15], s4 offen lds
s_add_u32 s36, s36, 81920
s_cmp_eq_u32 s36, s39
s_cselect_b32 s36, s38, s36
s_waitcnt vmcnt(15)
s_barrier
s_waitcnt vmcnt(10)
s_barrier
s_waitcnt vmcnt(5)
s_barrier
s_waitcnt vmcnt(0)
s_barrier
s_barrier
s_barrier
s_endpgm
K3_END:
s_endpgm
.section .rodata,"a"
.p2align 6
.amdhsa_kernel proj_kernel
.amdhsa_next_free_vgpr 120
.amdhsa_next_free_sgpr 102
.amdhsa_accum_offset 120
.amdhsa_group_segment_fixed_size 0
.amdhsa_kernarg_size 96
.amdhsa_user_sgpr_count 2
.amdhsa_user_sgpr_kernarg_segment_ptr 1
.amdhsa_system_sgpr_workgroup_id_x 1
.end_amdhsa_kernel
.p2align 6
.amdhsa_kernel attn_kernel
.amdhsa_next_free_vgpr 152
.amdhsa_next_free_sgpr 102
.amdhsa_accum_offset 152
.amdhsa_group_segment_fixed_size 0
.amdhsa_kernarg_size 96
.amdhsa_user_sgpr_count 2
.amdhsa_user_sgpr_kernarg_segment_ptr 1
.amdhsa_system_sgpr_workgroup_id_x 1
.end_amdhsa_kernel
.p2align 6
.amdhsa_kernel oproj_kernel
.amdhsa_next_free_vgpr 200
.amdhsa_next_free_sgpr 102
.amdhsa_accum_offset 104
.amdhsa_group_segment_fixed_size 0
.amdhsa_kernarg_size 96
.amdhsa_user_sgpr_count 2
.amdhsa_user_sgpr_kernarg_segment_ptr 1
.amdhsa_system_sgpr_workgroup_id_x 1
.end_amdhsa_kernel
```
